```python
import torch

def _softmax(x, axis=-1):
    return torch.softmax(x, dim=axis)
def _gelu(x):
    return torch.nn.functional.gelu(x, approximate="tanh")
def _silu(x):
    return torch.nn.functional.silu(x)
def _sigmoid(x):
    return torch.sigmoid(x)
def _layernorm(x, axis=-1, eps=1e-5):
    m = x.mean(dim=axis, keepdim=True)
    v = x.var(dim=axis, keepdim=True, unbiased=False)
    return (x - m) / torch.sqrt(v + eps)
def _scatter_add(tgt, idx, src, axis=0):
    return tgt.clone().index_add_(axis, idx, src)
def _segment_sum(src, seg, n):
    out = torch.zeros((n,) + src.shape[1:], dtype=src.dtype)
    return out.index_add_(0, seg, src)
def _pad(x, pw):
    flat = tuple(v for pair in reversed(pw) for v in pair)
    return torch.nn.functional.pad(x, flat)

kernel_name = 'parallel_sum__softmax_full_mha__glu_gated_geglu__prompt'

def setup_inputs():

    _w = (lambda a: (lambda t: t.to(torch.bfloat16) if t.is_floating_point() else t)(torch.as_tensor(a)))
    def _A_setup():
        B, S, D = 1, 2048, 512
        return {
            "x": _w((lambda *s: torch.randn(*s, dtype=torch.bfloat16) * 0.05)(B, S, D)),
            "wqkv": _w((lambda *s: torch.randn(*s, dtype=torch.bfloat16) * 0.05)(D, 3 * D)),
            "wo": _w((lambda *s: torch.randn(*s, dtype=torch.bfloat16) * 0.05)(D, D)),
        }
    _A_in = _A_setup()

    def _B_setup():
        B, S, Dm, Df = 1, 2048, 512, 1792
        return {
            "x": _w((lambda *s: torch.randn(*s, dtype=torch.bfloat16) * 0.05)(B, S, Dm)),
            "w_gate": _w((lambda *s: torch.randn(*s, dtype=torch.bfloat16) * 0.4)(Dm, Df) * (Dm ** -0.5)),
            "w_up": _w((lambda *s: torch.randn(*s, dtype=torch.bfloat16) * 0.4)(Dm, Df) * (Dm ** -0.5)),
            "w_down": _w((lambda *s: torch.randn(*s, dtype=torch.bfloat16) * 0.4)(Df, Dm) * (Df ** -0.5)),
        }
    _B_in = _B_setup()

    return {
        "A_x": _A_in["x"],
        "A_wqkv": _A_in["wqkv"],
        "A_wo": _A_in["wo"],
        "B_x": _B_in["x"],
        "B_w_gate": _B_in["w_gate"],
        "B_w_up": _B_in["w_up"],
        "B_w_down": _B_in["w_down"],
    }

def reference(A_x, A_wqkv, A_wo, B_x, B_w_gate, B_w_up, B_w_down):
    def _A_ref(x, wqkv, wo):
        B, S, D = x.shape
        H = 32; Dh = D // H
        qkv = (lambda x, *d: x.permute(*d))((x @ wqkv).reshape(B, S, 3, H, Dh), 2, 0, 3, 1, 4)
        q, k, v = qkv[0], qkv[1], qkv[2]
        scale = Dh ** -0.5
        scores = torch.einsum("bhqd,bhkd->bhqk", q, k) * scale
        p = _softmax(scores, axis=-1)
        o = torch.einsum("bhqk,bhkd->bhqd", p, v)
        return (lambda x, *d: x.permute(*d))(o, 0, 2, 1, 3).reshape(B, S, D) @ wo

    def _B_ref(x, w_gate, w_up, w_down):
        g = torch.einsum("bsd,df->bsf", x, w_gate)
        u = torch.einsum("bsd,df->bsf", x, w_up)
        h = _gelu(g) * u
        return torch.einsum("bsf,fd->bsd", h, w_down)

    x = A_x
    xn = _layernorm(x, axis=-1)
    return x + _A_ref(xn, A_wqkv, A_wo) + _B_ref(xn, B_w_gate, B_w_up, B_w_down)
```

```asm
; @launch grid=(256,1,1) block=(768,1,1) lds=163840
.amdgcn_target "amdgcn-amd-amdhsa--gfx950"
.text
.globl parallel_sum__softmax_full_mha__glu_gated_geglu__prompt_kernel
.p2align 8
.type parallel_sum__softmax_full_mha__glu_gated_geglu__prompt_kernel,@function
parallel_sum__softmax_full_mha__glu_gated_geglu__prompt_kernel:
L_start:
    s_cmp_ge_u32 s2, 256
    s_cbranch_scc1 L_end
    s_load_dwordx16 s[4:19], s[0:1], 0
    s_load_dwordx4 s[20:23], s[0:1], 64
    s_getpc_b64 s[30:31]
L_pc:
    s_lshr_b32 s42, s2, 3
    v_lshrrev_b32 v1, 6, v0
    s_mul_i32 s37, s42, 12
    v_add_lshl_u32 v165, v1, s37, 7
    v_min_u32 v165, (L_end - L_pc), v165
    s_mov_b64 exec, 1
    global_load_dword v165, v165, s[30:31]
    s_mov_b64 exec, -1
    v_and_b32 v2, 63, v0
    v_readfirstlane_b32 s36, v1
    v_lshlrev_b32 v3, 4, v2
    s_and_b32 s41, s2, 7
    s_lshr_b32 s43, s41, 1
    s_lshl_b32 s43, s43, 3
    s_and_b32 s37, s42, 7
    s_add_u32 s43, s43, s37
    s_and_b32 s44, s41, 1
    s_lshl_b32 s44, s44, 2
    s_lshr_b32 s37, s42, 3
    s_add_u32 s44, s44, s37
    s_lshl_b32 s56, s42, 1
    s_and_b32 s56, s56, 15
    s_and_b32 s37, s37, 1
    s_lshl3_add_u32 s37, s37, s36
    s_lshl4_add_u32 s37, s43, s37
    s_lshl_b32 s37, s37, 12
    s_xor_b32 s38, s37, 32768
    v_lshrrev_b32 v164, 4, v2
    v_mul_u32_u24 v164, 768, v164
    v_add_u32 v164, v164, v3
    s_cmp_lt_u32 s36, 8
    s_waitcnt lgkmcnt(0)
    s_mov_b64 s[32:33], s[4:5]
    s_mov_b32 s34, 0x200000
    s_mov_b32 s35, 0x00020000
    s_cbranch_scc0 L_norow
    buffer_load_dwordx4 v[132:135], v164, s[32:35], s37 offen offset:0
    buffer_load_dwordx4 v[136:139], v164, s[32:35], s37 offen offset:256
    buffer_load_dwordx4 v[140:143], v164, s[32:35], s37 offen offset:512
    buffer_load_dwordx4 v[144:147], v164, s[32:35], s37 offen offset:768
L_norow:
    s_add_u32 s62, s22, 33554432
    s_addc_u32 s63, s23, 0
    s_load_dword s60, s[62:63], 0
    s_mov_b64 s[24:25], s[22:23]
    s_mov_b32 s26, 0x10000000
    s_mov_b32 s27, 0x00020000
    s_mov_b32 s3, 0x3f803f80
    s_cmp_lt_u32 s36, 8
    s_cbranch_scc1 L_role_a
    s_sub_u32 s47, s36, 8
    s_setprio 2
    s_mov_b64 s[28:29], s[6:7]
    s_mov_b32 s30, 0x180000
    s_mov_b32 s31, 0x00020000
    v_lshrrev_b32 v6, 3, v2
    v_and_b32 v9, 7, v2
    v_lshlrev_b32 v8, 1, v6
    v_and_b32 v8, 4, v8
    v_xor_b32 v7, v9, v8
    v_mul_u32_u24 v8, 3072, v6
    v_lshl_add_u32 v8, v7, 4, v8
    s_mul_i32 s10, s47, 49152
    s_lshl_b32 s37, s44, 7
    s_add_u32 s10, s10, s37
    s_mul_i32 s11, s47, 6144
    s_add_u32 s11, s11, 65536
    s_and_b32 s20, s42, 7
    s_mov_b32 s21, 24704
    s_mov_b32 s48, 0
    s_cmp_ge_u32 s47, 2
    s_cselect_b64 s[12:13], s[14:15], s[12:13]
    s_cselect_b32 s50, 12320, 0
    s_add_u32 s50, s50, 65536
    s_mov_b32 s14, 0x1c0000
    s_mov_b32 s15, 0x00020000
    v_add_u32 v4, 0, v2
    v_mul_u32_u24 v5, 5462, v4
    v_lshrrev_b32 v5, 16, v5
    v_mul_u32_u24 v5, 3392, v5
    v_lshl_add_u32 v5, v4, 4, v5
    v_subrev_u32 v16, 0, v5
    v_add_u32 v4, 64, v2
    v_mul_u32_u24 v5, 5462, v4
    v_lshrrev_b32 v5, 16, v5
    v_mul_u32_u24 v5, 3392, v5
    v_lshl_add_u32 v5, v4, 4, v5
    v_subrev_u32 v17, 1024, v5
    v_add_u32 v4, 128, v2
    v_mul_u32_u24 v5, 5462, v4
    v_lshrrev_b32 v5, 16, v5
    v_mul_u32_u24 v5, 3392, v5
    v_lshl_add_u32 v5, v4, 4, v5
    v_subrev_u32 v18, 2048, v5
    v_add_u32 v4, 192, v2
    v_mul_u32_u24 v5, 5462, v4
    v_lshrrev_b32 v5, 16, v5
    v_mul_u32_u24 v5, 3392, v5
    v_lshl_add_u32 v5, v4, 4, v5
    v_subrev_u32 v19, 3072, v5
    v_add_u32 v4, 256, v2
    v_mul_u32_u24 v5, 5462, v4
    v_lshrrev_b32 v5, 16, v5
    v_mul_u32_u24 v5, 3392, v5
    v_lshl_add_u32 v5, v4, 4, v5
    v_subrev_u32 v20, 0, v5
    v_add_u32 v4, 320, v2
    v_mul_u32_u24 v5, 5462, v4
    v_lshrrev_b32 v5, 16, v5
    v_mul_u32_u24 v5, 3392, v5
    v_lshl_add_u32 v5, v4, 4, v5
    v_subrev_u32 v21, 1024, v5
    s_and_b32 s38, s47, 1
    s_mul_i32 s55, s38, 114688
    s_mul_i32 s39, s44, 192
    s_add_u32 s49, s55, s39
    s_add_u32 s49, s49, 2048
    s_mul_i32 s38, s38, 6144
    s_add_u32 s50, s50, s38
    s_waitcnt lgkmcnt(0)
    s_add_u32 s60, s60, 1
    s_xor_b32 s61, s60, 0x5bd1e995
    v_mov_b32 v166, s60
    v_mov_b32 v167, s61
    s_mul_i32 s53, s20, 229376
    s_add_u32 s53, s53, s49
    v_lshrrev_b32 v4, 1, v2
    v_mul_u32_u24 v4, 3584, v4
    v_and_b32 v5, 1, v2
    v_lshl_add_u32 v23, v5, 7, v4
    s_lshl_b32 s51, s44, 5
    s_add_u32 s51, s51, s43
    s_lshl_b32 s51, s51, 7
    s_add_u32 s51, s51, 33685504
    s_lshl3_add_u32 s52, s43, s44
    s_lshl_b32 s52, s52, 7
    s_add_u32 s52, s52, 33751040
    s_lshl_b32 s58, s41, 12
    s_add_u32 s58, s58, 33685504
    v_mov_b32 v164, 156032
    v_mov_b32 v1, 1
    s_mov_b64 s[32:33], s[22:23]
    s_mov_b32 s34, 0x10000000
    s_mov_b32 s35, 0x00020000
    v_mov_b32 v136, 0
    v_mov_b32 v137, 0
    v_mov_b32 v138, 0
    v_mov_b32 v139, 0
    s_waitcnt vmcnt(0)
L_d_issue:
    s_mul_i32 s39, s20, 196608
    s_add_u32 s39, s39, s10
    s_add_u32 m0, s11, s21
    s_add_u32 s20, s20, 1
    buffer_load_dwordx4 v8, s[28:31], s39 offen offset:0 lds
    buffer_load_dwordx4 v8, s[28:31], s39 offen offset:1024 lds
    buffer_load_dwordx4 v8, s[28:31], s39 offen offset:2048 lds
    s_add_u32 m0, m0, 3072
    s_add_u32 s39, s39, 24576
    buffer_load_dwordx4 v8, s[28:31], s39 offen offset:0 lds
    buffer_load_dwordx4 v8, s[28:31], s39 offen offset:1024 lds
    buffer_load_dwordx4 v8, s[28:31], s39 offen offset:2048 lds
    s_and_b32 s20, s20, 7
    s_add_u32 s21, s21, 24704
    s_cmp_eq_u32 s21, 74112
    s_cselect_b32 s21, 0, s21
    s_add_u32 s48, s48, 1
    s_cmp_lt_u32 s48, 3
    s_cbranch_scc1 L_d_issue
    s_cmp_lg_u32 s48, 3
    s_cbranch_scc1 L_d_w
    buffer_load_dword v23, v23, s[12:15], s53 offen
    s_lshr_b32 s43, s41, 2
    s_and_b32 s57, s42, 7
    s_lshl3_add_u32 s43, s43, s57
    s_and_b32 s44, s41, 3
    s_lshr_b32 s39, s42, 3
    s_lshl2_add_u32 s44, s44, s39
    s_lshl1_add_u32 s57, s39, s57
    s_and_b32 s57, s57, 7
    s_lshl2_add_u32 s37, s43, s47
    s_lshl_b32 s54, s37, 15
    s_lshr_b32 s59, s37, 1
    s_lshl_b32 s59, s59, 10
    s_add_u32 s59, s59, 33619968
    s_mul_i32 s3, s37, 147456
    s_lshl_b32 s38, s44, 12
    s_add_u32 s3, s3, s38
    s_add_u32 s3, s3, 8421376
    s_lshl_b32 s38, s44, 7
    s_add_u32 s55, s55, s38
    s_lshl_b32 s56, s47, 12
    s_add_u32 s56, s56, 106880
    s_lshl4_add_u32 s63, s43, s44
    s_lshl_b32 s63, s63, 7
    s_add_u32 s63, s63, 33882112
    v_and_b32 v4, 2, v6
    s_and_b32 s38, s47, 2
    s_lshl_b32 s38, s38, 1
    v_or_b32 v4, s38, v4
    v_xor_b32 v4, v4, v9
    v_mul_u32_u24 v5, 3584, v6
    v_lshl_add_u32 v136, v4, 4, v5
    v_add_u32 v137, 27648, v136
    v_add_u32 v138, 55296, v136
    v_add_u32 v139, 82944, v136
    v_bfe_u32 v4, v2, 2, 2
    v_lshrrev_b32 v5, 5, v2
    v_lshl_add_u32 v5, v5, 3, v4
    v_lshlrev_b32 v5, 7, v5
    v_lshrrev_b32 v4, 1, v4
    v_lshl_add_u32 v5, v4, 5, v5
    v_bfe_u32 v4, v2, 4, 1
    v_mul_u32_u24 v4, 8256, v4
    v_and_b32 v10, 3, v2
    v_lshl_add_u32 v4, v10, 3, v4
    v_add_u32 v128, v4, v5
    v_add_u32 v128, 106880, v128
    v_mov_b64 v[64:65], 0
    v_mov_b64 v[66:67], 0
    v_mov_b64 v[68:69], 0
    v_mov_b64 v[70:71], 0
    v_mov_b64 v[72:73], 0
    v_mov_b64 v[74:75], 0
    v_mov_b64 v[76:77], 0
    v_mov_b64 v[78:79], 0
    v_mov_b64 v[80:81], 0
    v_mov_b64 v[82:83], 0
    v_mov_b64 v[84:85], 0
    v_mov_b64 v[86:87], 0
    v_mov_b64 v[88:89], 0
    v_mov_b64 v[90:91], 0
    v_mov_b64 v[92:93], 0
    v_mov_b64 v[94:95], 0
    v_mov_b64 v[96:97], 0
    v_mov_b64 v[98:99], 0
    v_mov_b64 v[100:101], 0
    v_mov_b64 v[102:103], 0
    v_mov_b64 v[104:105], 0
    v_mov_b64 v[106:107], 0
    v_mov_b64 v[108:109], 0
    v_mov_b64 v[110:111], 0
    v_mov_b64 v[112:113], 0
    v_mov_b64 v[114:115], 0
    v_mov_b64 v[116:117], 0
    v_mov_b64 v[118:119], 0
    v_mov_b64 v[120:121], 0
    v_mov_b64 v[122:123], 0
    v_mov_b64 v[124:125], 0
    v_mov_b64 v[126:127], 0
    s_waitcnt vmcnt(13)
    s_barrier
L_d_w:
    s_waitcnt vmcnt(7)
    s_cmp_lt_u32 s48, 5
    s_cbranch_scc1 L_d_b
    s_waitcnt vmcnt(6)
L_d_b:
    s_barrier
    s_lshl4_add_u32 s37, s47, s48
    s_cmp_lg_u32 s37, 5
    s_cbranch_scc1 L_d_nf
    s_add_u32 s37, s52, 4294836224
    s_mov_b64 exec, 1
    buffer_store_dwordx2 v[166:167], v3, s[24:27], s37 offen sc0 sc1
    s_mov_b64 exec, -1
L_d_nf:
    s_cmp_lg_u32 s48, 8
    s_cbranch_scc1 L_d_issue
    v_lshlrev_b32 v165, 7, v2
L_g_issue:
    s_mul_i32 s39, s20, 229376
    s_add_u32 m0, s50, s21
    s_add_u32 s39, s39, s49
    buffer_load_dwordx4 v16, s[12:15], s39 offen offset:0 lds
    buffer_load_dwordx4 v17, s[12:15], s39 offen offset:1024 lds
    buffer_load_dwordx4 v18, s[12:15], s39 offen offset:2048 lds
    buffer_load_dwordx4 v19, s[12:15], s39 offen offset:3072 lds
    s_add_u32 m0, m0, 4096
    s_add_u32 s20, s20, 1
    buffer_load_dwordx4 v20, s[12:15], s39 offen offset:0 lds
    buffer_load_dwordx4 v21, s[12:15], s39 offen offset:1024 lds
    s_and_b32 s20, s20, 7
    s_add_u32 s21, s21, 24704
    s_cmp_eq_u32 s21, 74112
    s_cselect_b32 s21, 0, s21
    s_add_u32 s48, s48, 1
    s_waitcnt vmcnt(6)
    s_barrier
    s_lshl_b32 s37, s47, 5
    s_add_u32 s37, s37, s48
    s_cmp_lg_u32 s37, 12
    s_cbranch_scc1 L_g_nf
    s_mov_b64 exec, 1
    buffer_store_dwordx2 v[166:167], v3, s[24:27], s51 offen sc0 sc1
    s_mov_b64 exec, -1
L_g_nf:
    s_cmp_lg_u32 s48, 16
    s_cbranch_scc1 L_g_issue
    s_mov_b32 s21, 32768
    s_mov_b32 s49, 32768
    s_mov_b32 s50, s57
    s_mov_b32 s10, 0
    s_mov_b32 s11, 4
    s_mov_b32 s20, 0
    s_mov_b32 exec_hi, 0
    buffer_load_dwordx2 v[26:27], v165, s[24:27], s58 offen sc1
    s_mov_b64 exec, 0xff
    buffer_load_dwordx2 v[24:25], v165, s[24:27], s59 offen sc1
    s_mov_b64 exec, -1
    s_mul_i32 s39, s57, 229376
    s_add_u32 m0, s56, 32768
    s_add_u32 s39, s39, s55
    buffer_load_dwordx4 v136, s[12:15], s39 offen offset:0 lds
    buffer_load_dwordx4 v137, s[12:15], s39 offen offset:1024 lds
    buffer_load_dwordx4 v138, s[12:15], s39 offen offset:2048 lds
    buffer_load_dwordx4 v139, s[12:15], s39 offen offset:3072 lds
    s_mul_i32 s39, s57, 229376
    s_add_u32 s39, s39, s55
    s_add_u32 m0, s56, s21
    s_add_u32 s57, s57, 1
    s_and_b32 s57, s57, 7
    s_add_u32 s21, s21, 16384
    s_cmp_eq_u32 s21, 49152
    s_cselect_b32 s21, 0, s21
    s_lshl_b32 s51, s50, 12
    s_add_u32 s51, s51, s54
    s_add_u32 s50, s50, 1
    s_and_b32 s50, s50, 7
    v_add_u32 v132, s49, v128
    v_xor_b32 v133, 32, v132
    v_xor_b32 v134, 64, v132
    v_xor_b32 v135, 96, v132
    s_waitcnt vmcnt(4)
    s_barrier
    v_cmp_ne_u64 vcc, s[60:61], v[26:27]
    s_lshr_b32 s40, s42, 3
    s_lshl2_add_u32 s40, s41, s40
    s_cmp_eq_u32 vcc_lo, 0
    s_cbranch_scc1 L_f_nopoll
    s_mov_b32 s62, 0x20000
    s_mov_b32 exec_lo, 0xffffffff
    s_mov_b32 exec_hi, 0
L_f_pollq:
    buffer_load_dwordx2 v[26:27], v165, s[24:27], s58 offen sc1
    s_waitcnt vmcnt(0)
    v_cmp_ne_u64 vcc, s[60:61], v[26:27]
    s_sub_u32 s62, s62, 1
    s_cbranch_scc1 L_f_pollq_ok
    s_cbranch_vccz L_f_pollq_ok
    s_sleep 2
    s_branch L_f_pollq
L_f_pollq_ok:
    s_mov_b64 exec, -1
L_f_nopoll:
    s_lshl_b32 s40, s40, 17
    s_lshl_b32 s37, s47, 12
    s_add_u32 m0, s37, 65536
    s_add_u32 s40, s40, s37
    s_add_u32 s40, s40, 4194304
    buffer_load_dwordx4 v3, s[24:27], s40 offen offset:0 sc1 lds
    buffer_load_dwordx4 v3, s[24:27], s40 offen offset:1024 sc1 lds
    buffer_load_dwordx4 v3, s[24:27], s40 offen offset:2048 sc1 lds
    buffer_load_dwordx4 v3, s[24:27], s40 offen offset:3072 sc1 lds
    v_cmp_ne_u64 vcc, s[60:61], v[24:25]
    s_mul_i32 s39, s57, 229376
    s_add_u32 s39, s39, s55
    s_add_u32 m0, s56, s21
    s_add_u32 s57, s57, 1
    s_and_b32 s57, s57, 7
    s_add_u32 s21, s21, 16384
    s_cmp_eq_u32 s21, 49152
    s_cselect_b32 s21, 0, s21
    s_barrier
    s_waitcnt vmcnt(0)
    s_mov_b64 exec, 1
    ds_add_u32 v164, v1 offset:28
    s_mov_b64 exec, -1
    s_setprio 2
    s_and_b32 s37, vcc_lo, 0xff
    s_cbranch_scc0 L_f_xok
    s_mov_b32 s62, 0x20000
    s_mov_b32 exec_lo, 0xff
    s_mov_b32 exec_hi, 0
L_f_pollx:
    buffer_load_dwordx2 v[24:25], v165, s[24:27], s59 offen sc1
    s_waitcnt vmcnt(0)
    v_cmp_ne_u64 vcc, s[60:61], v[24:25]
    s_sub_u32 s62, s62, 1
    s_cbranch_scc1 L_f_pollx_ok
    s_cbranch_vccz L_f_pollx_ok
    s_sleep 2
    s_branch L_f_pollx
L_f_pollx_ok:
    s_mov_b64 exec, -1
L_f_xok:
    buffer_load_dwordx4 v[8:11], v3, s[32:35], s51 offen offset:0 sc1
    buffer_load_dwordx4 v[12:15], v3, s[32:35], s51 offen offset:1024 sc1
    buffer_load_dwordx4 v[16:19], v3, s[32:35], s51 offen offset:2048 sc1
    buffer_load_dwordx4 v136, s[12:15], s39 offen offset:0 lds
    buffer_load_dwordx4 v137, s[12:15], s39 offen offset:1024 lds
    buffer_load_dwordx4 v138, s[12:15], s39 offen offset:2048 lds
    buffer_load_dwordx4 v139, s[12:15], s39 offen offset:3072 lds
    buffer_load_dwordx4 v[20:23], v3, s[32:35], s51 offen offset:3072 sc1
    s_waitcnt vmcnt(5)
    s_mov_b64 exec, 1
    ds_add_u32 v164, v1 offset:44
    s_mov_b64 exec, -1
    s_mov_b32 s62, 0x200000
L_f_g0:
    ds_read_b32 v0, v164 offset:44
    s_waitcnt lgkmcnt(0)
    v_readfirstlane_b32 s37, v0
    s_nop 0
    s_cmp_ge_u32 s37, 4
    s_cbranch_scc1 L_f_g0_ok
    s_sleep 1
    s_sub_u32 s62, s62, 1
    s_cbranch_scc0 L_f_g0
L_f_g0_ok:
    s_mov_b32 s62, 0x200000
L_f_gate:
    ds_read_b32 v0, v164 offset:0
    s_waitcnt lgkmcnt(0)
    v_readfirstlane_b32 s37, v0
    s_nop 0
    s_cmp_ge_u32 s37, 8
    s_cbranch_scc1 L_f_gate_ok
    s_sleep 1
    s_sub_u32 s62, s62, 1
    s_cbranch_scc0 L_f_gate
L_f_gate_ok:
    ds_read_b64_tr_b16 v[24:25], v132 offset:0
    ds_read_b64_tr_b16 v[26:27], v132 offset:512
    ds_read_b64_tr_b16 v[28:29], v133 offset:0
    ds_read_b64_tr_b16 v[30:31], v133 offset:512
    ds_read_b64_tr_b16 v[32:33], v134 offset:0
    ds_read_b64_tr_b16 v[34:35], v134 offset:512
    s_waitcnt lgkmcnt(0)
L_f_loop:
    s_cmp_lt_u32 s10, 6
    s_cselect_b32 s14, s14, 0
    s_mul_i32 s39, s57, 229376
    s_add_u32 s39, s39, s55
    s_add_u32 m0, s56, s21
    s_add_u32 s57, s57, 1
    s_and_b32 s57, s57, 7
    s_add_u32 s21, s21, 16384
    s_cmp_eq_u32 s21, 49152
    s_cselect_b32 s21, 0, s21
    s_lshl_b32 s51, s50, 12
    s_add_u32 s51, s51, s54
    s_cmp_lt_u32 s10, 7
    s_cselect_b32 s34, s34, 0
    s_add_u32 s50, s50, 1
    s_and_b32 s50, s50, 7
    ds_read_b64_tr_b16 v[36:37], v135 offset:0
    ds_read_b64_tr_b16 v[38:39], v135 offset:512
    s_waitcnt lgkmcnt(7) vmcnt(7)
    s_setprio 0
    v_mfma_f32_32x32x16_bf16 v[64:79], v[24:27], v[8:11], v[64:79]
    s_setprio 2
    ds_read_b32 v0, v164 offset:40
    ds_read_b64_tr_b16 v[40:41], v132 offset:2048
    ds_read_b64_tr_b16 v[42:43], v132 offset:2560
    s_waitcnt lgkmcnt(8)
    s_setprio 0
    v_mfma_f32_32x32x16_bf16 v[80:95], v[28:31], v[8:11], v[80:95]
    s_setprio 2
    ds_read_b64_tr_b16 v[44:45], v133 offset:2048
    ds_read_b64_tr_b16 v[46:47], v133 offset:2560
    s_waitcnt lgkmcnt(8)
    s_setprio 0
    v_mfma_f32_32x32x16_bf16 v[96:111], v[32:35], v[8:11], v[96:111]
    s_setprio 2
    ds_read_b64_tr_b16 v[48:49], v134 offset:2048
    ds_read_b64_tr_b16 v[50:51], v134 offset:2560
    s_waitcnt lgkmcnt(7)
    s_setprio 0
    v_mfma_f32_32x32x16_bf16 v[112:127], v[36:39], v[8:11], v[112:127]
    s_setprio 2
    buffer_load_dwordx4 v[8:11], v3, s[32:35], s51 offen offset:0 sc1
    ds_read_b64_tr_b16 v[52:53], v135 offset:2048
    ds_read_b64_tr_b16 v[54:55], v135 offset:2560
    s_waitcnt lgkmcnt(6) vmcnt(5)
    s_setprio 0
    v_mfma_f32_32x32x16_bf16 v[64:79], v[40:43], v[12:15], v[64:79]
    s_setprio 2
    v_readfirstlane_b32 s37, v0
    s_nop 0
    s_cmp_ge_u32 s37, s20
    s_cbranch_scc0 L_f_d_slow
L_f_d_back:
    ds_read_b64_tr_b16 v[24:25], v132 offset:4096
    ds_read_b64_tr_b16 v[26:27], v132 offset:4608
    s_waitcnt lgkmcnt(6)
    s_setprio 0
    v_mfma_f32_32x32x16_bf16 v[80:95], v[44:47], v[12:15], v[80:95]
    s_setprio 2
    buffer_load_dwordx4 v136, s[12:15], s39 offen offset:0 lds
    ds_read_b64_tr_b16 v[28:29], v133 offset:4096
    ds_read_b64_tr_b16 v[30:31], v133 offset:4608
    s_waitcnt lgkmcnt(6) vmcnt(3)
    s_setprio 0
    v_mfma_f32_32x32x16_bf16 v[96:111], v[48:51], v[12:15], v[96:111]
    s_setprio 2
    s_mov_b64 exec, 1
    ds_add_u32 v164, v1 offset:4
    s_mov_b64 exec, -1
    ds_read_b64_tr_b16 v[32:33], v134 offset:4096
    ds_read_b64_tr_b16 v[34:35], v134 offset:4608
    s_waitcnt lgkmcnt(7)
    s_setprio 0
    v_mfma_f32_32x32x16_bf16 v[112:127], v[52:55], v[12:15], v[112:127]
    s_setprio 2
    buffer_load_dwordx4 v137, s[12:15], s39 offen offset:1024 lds
    buffer_load_dwordx4 v[12:15], v3, s[32:35], s51 offen offset:1024 sc1
    ds_read_b64_tr_b16 v[36:37], v135 offset:4096
    ds_read_b64_tr_b16 v[38:39], v135 offset:4608
    s_waitcnt lgkmcnt(7) vmcnt(5)
    s_setprio 0
    v_mfma_f32_32x32x16_bf16 v[64:79], v[24:27], v[16:19], v[64:79]
    s_setprio 2
    ds_read_b32 v0, v164 offset:4
    ds_read_b64_tr_b16 v[40:41], v132 offset:6144
    ds_read_b64_tr_b16 v[42:43], v132 offset:6656
    s_waitcnt lgkmcnt(8)
    s_setprio 0
    v_mfma_f32_32x32x16_bf16 v[80:95], v[28:31], v[16:19], v[80:95]
    s_setprio 2
    buffer_load_dwordx4 v138, s[12:15], s39 offen offset:2048 lds
    ds_read_b64_tr_b16 v[44:45], v133 offset:6144
    ds_read_b64_tr_b16 v[46:47], v133 offset:6656
    s_waitcnt lgkmcnt(7)
    s_setprio 0
    v_mfma_f32_32x32x16_bf16 v[96:111], v[32:35], v[16:19], v[96:111]
    s_setprio 2
    ds_read_b64_tr_b16 v[48:49], v134 offset:6144
    ds_read_b64_tr_b16 v[50:51], v134 offset:6656
    s_waitcnt lgkmcnt(7)
    s_setprio 0
    v_mfma_f32_32x32x16_bf16 v[112:127], v[36:39], v[16:19], v[112:127]
    s_setprio 2
    buffer_load_dwordx4 v139, s[12:15], s39 offen offset:3072 lds
    buffer_load_dwordx4 v[16:19], v3, s[32:35], s51 offen offset:2048 sc1
    ds_read_b64_tr_b16 v[52:53], v135 offset:6144
    ds_read_b64_tr_b16 v[54:55], v135 offset:6656
    s_waitcnt lgkmcnt(6) vmcnt(7)
    s_setprio 0
    v_mfma_f32_32x32x16_bf16 v[64:79], v[40:43], v[20:23], v[64:79]
    s_setprio 2
    v_readfirstlane_b32 s37, v0
    s_add_u32 s49, s49, 16384
    s_cmp_eq_u32 s49, 49152
    s_cselect_b32 s49, 0, s49
    v_add_u32 v132, s49, v128
    v_xor_b32 v133, 32, v132
    v_xor_b32 v134, 64, v132
    v_xor_b32 v135, 96, v132
    s_cmp_ge_u32 s37, s11
    s_cbranch_scc0 L_f_r_slow
L_f_r_back:
    ds_read_b64_tr_b16 v[24:25], v132 offset:0
    ds_read_b64_tr_b16 v[26:27], v132 offset:512
    s_waitcnt lgkmcnt(6)
    s_setprio 0
    v_mfma_f32_32x32x16_bf16 v[80:95], v[44:47], v[20:23], v[80:95]
    s_setprio 2
    ds_read_b64_tr_b16 v[28:29], v133 offset:0
    ds_read_b64_tr_b16 v[30:31], v133 offset:512
    s_waitcnt lgkmcnt(6)
    s_setprio 0
    v_mfma_f32_32x32x16_bf16 v[96:111], v[48:51], v[20:23], v[96:111]
    s_setprio 2
    ds_read_b64_tr_b16 v[32:33], v134 offset:0
    ds_read_b64_tr_b16 v[34:35], v134 offset:512
    s_waitcnt lgkmcnt(6)
    s_setprio 0
    v_mfma_f32_32x32x16_bf16 v[112:127], v[52:55], v[20:23], v[112:127]
    s_setprio 2
    s_mov_b64 exec, 1
    ds_add_u32 v164, v1 offset:40
    s_mov_b64 exec, -1
    buffer_load_dwordx4 v[20:23], v3, s[32:35], s51 offen offset:3072 sc1
    s_add_u32 s11, s11, 4
    s_add_u32 s20, s20, 4
    s_add_u32 s10, s10, 1
    s_cmp_lt_u32 s10, 8
    s_cbranch_scc1 L_f_loop
    s_setprio 2
    s_waitcnt vmcnt(0) lgkmcnt(0)
    s_mov_b64 exec, 1
    ds_add_u32 v164, v1 offset:40
    s_mov_b64 exec, -1
    s_cmp_lg_u32 s47, 0
    s_cbranch_scc1 L_f_hf
    s_mov_b32 s62, 0x200000
L_f_nofw1:
    ds_read_b32 v0, v164 offset:0
    s_waitcnt lgkmcnt(0)
    v_readfirstlane_b32 s37, v0
    s_nop 0
    s_cmp_ge_u32 s37, 16
    s_cbranch_scc1 L_f_nofw1_ok
    s_sleep 8
    s_sub_u32 s62, s62, 1
    s_cbranch_scc0 L_f_nofw1
L_f_nofw1_ok:
    s_mov_b64 exec, 1
    buffer_store_dwordx2 v[166:167], v3, s[24:27], s52 offen sc0 sc1
    s_mov_b64 exec, -1
L_f_hf:
    s_and_b32 s39, s42, 3
    s_lshl2_add_u32 s43, s41, s39
    s_lshr_b32 s44, s42, 2
    s_mov_b64 s[28:29], s[16:17]
    s_mov_b32 s30, 0x1c0000
    s_mov_b32 s31, 0x00020000
    s_mov_b64 s[32:33], s[8:9]
    s_mov_b32 s34, 0x80000
    s_mov_b32 s35, 0x00020000
    v_lshrrev_b32 v8, 3, v2
    v_lshlrev_b32 v7, 1, v8
    v_and_b32 v7, 4, v7
    v_and_b32 v9, 7, v2
    v_xor_b32 v7, v7, v9
    v_lshlrev_b32 v8, 10, v8
    v_lshl_add_u32 v8, v7, 4, v8
    v_add_u32 v9, 7168, v8
    v_add_u32 v10, 14336, v8
    v_add_u32 v11, 21504, v8
    s_lshl_b32 s45, s44, 7
    s_mul_i32 s56, s47, 20480
    s_add_u32 s56, s56, 65536
    s_lshl1_add_u32 s20, s39, s44
    s_and_b32 s20, s20, 7
    s_sub_u32 s39, s20, 6
    s_cmp_ge_u32 s20, 6
    s_cselect_b32 s54, s39, s20
    s_mov_b32 s55, s54
    s_and_b32 s38, s47, 1
    s_lshl1_add_u32 s38, s43, s38
    s_mul_i32 s46, s38, 147456
    s_xor_b32 s38, s38, 1
    s_mul_i32 s53, s38, 147456
    s_add_u32 s46, s46, 8388608
    s_add_u32 s53, s53, 8388608
    s_mul_i32 s57, s47, 6
    s_add_u32 s57, s57, 32
    s_lshl_b32 s58, s47, 3
    s_mov_b32 s62, 0x200000
L_f_spin2:
    ds_read_b32 v0, v164 offset:40
    s_waitcnt lgkmcnt(0)
    v_readfirstlane_b32 s37, v0
    s_nop 0
    s_cmp_ge_u32 s37, 36
    s_cbranch_scc1 L_f_spin2_ok
    s_sleep 1
    s_sub_u32 s62, s62, 1
    s_cbranch_scc0 L_f_spin2
L_f_spin2_ok:
    s_add_u32 m0, s56, 0
    s_add_u32 s37, s57, s54
    s_add_u32 s54, s54, 1
    s_cmp_eq_u32 s54, 6
    s_cselect_b32 s54, 0, s54
    s_lshl_b32 s37, s37, 15
    s_add_u32 s37, s37, s45
    buffer_load_dwordx4 v8, s[28:31], s37 offen offset:0 lds
    buffer_load_dwordx4 v9, s[28:31], s37 offen offset:1024 lds
    buffer_load_dwordx4 v10, s[28:31], s37 offen offset:2048 lds
    buffer_load_dwordx4 v11, s[28:31], s37 offen offset:3072 lds
    s_add_u32 m0, s56, 4096
    s_add_u32 s37, s57, s54
    s_add_u32 s54, s54, 1
    s_cmp_eq_u32 s54, 6
    s_cselect_b32 s54, 0, s54
    s_lshl_b32 s37, s37, 15
    s_add_u32 s37, s37, s45
    buffer_load_dwordx4 v8, s[28:31], s37 offen offset:0 lds
    buffer_load_dwordx4 v9, s[28:31], s37 offen offset:1024 lds
    buffer_load_dwordx4 v10, s[28:31], s37 offen offset:2048 lds
    buffer_load_dwordx4 v11, s[28:31], s37 offen offset:3072 lds
    v_mov_b32 v12, 0xc0135761
    v_mul_f32 v24, v64, v64
    v_mul_f32 v25, v65, v65
    v_mul_f32 v26, v66, v66
    v_mul_f32 v27, v67, v67
    v_mul_f32 v28, v68, v68
    v_mul_f32 v29, v69, v69
    v_mul_f32 v30, v70, v70
    v_mul_f32 v31, v71, v71
    v_fmamk_f32 v24, v24, 0xbdd2d3e8, v12
    v_fmamk_f32 v25, v25, 0xbdd2d3e8, v12
    v_fmamk_f32 v26, v26, 0xbdd2d3e8, v12
    v_fmamk_f32 v27, v27, 0xbdd2d3e8, v12
    v_fmamk_f32 v28, v28, 0xbdd2d3e8, v12
    v_fmamk_f32 v29, v29, 0xbdd2d3e8, v12
    v_fmamk_f32 v30, v30, 0xbdd2d3e8, v12
    v_fmamk_f32 v31, v31, 0xbdd2d3e8, v12
    v_mul_f32 v24, v24, v64
    v_mul_f32 v25, v25, v65
    v_mul_f32 v26, v26, v66
    v_mul_f32 v27, v27, v67
    v_mul_f32 v28, v28, v68
    v_mul_f32 v29, v29, v69
    v_mul_f32 v30, v30, v70
    v_mul_f32 v31, v31, v71
    v_exp_f32 v24, v24
    v_exp_f32 v25, v25
    v_exp_f32 v26, v26
    v_exp_f32 v27, v27
    v_exp_f32 v28, v28
    v_exp_f32 v29, v29
    v_exp_f32 v30, v30
    v_exp_f32 v31, v31
    v_mul_f32 v64, v64, v72
    v_mul_f32 v65, v65, v73
    v_mul_f32 v66, v66, v74
    v_mul_f32 v67, v67, v75
    v_mul_f32 v68, v68, v76
    v_mul_f32 v69, v69, v77
    v_mul_f32 v70, v70, v78
    v_mul_f32 v71, v71, v79
    v_add_f32 v24, 1.0, v24
    v_add_f32 v25, 1.0, v25
    v_add_f32 v26, 1.0, v26
    v_add_f32 v27, 1.0, v27
    v_add_f32 v28, 1.0, v28
    v_add_f32 v29, 1.0, v29
    v_add_f32 v30, 1.0, v30
    v_add_f32 v31, 1.0, v31
    v_rcp_f32 v24, v24
    v_rcp_f32 v25, v25
    v_rcp_f32 v26, v26
    v_rcp_f32 v27, v27
    v_rcp_f32 v28, v28
    v_rcp_f32 v29, v29
    v_rcp_f32 v30, v30
    v_rcp_f32 v31, v31
    s_nop 0
    v_mul_f32 v64, v64, v24
    v_mul_f32 v65, v65, v25
    v_mul_f32 v66, v66, v26
    v_mul_f32 v67, v67, v27
    v_mul_f32 v68, v68, v28
    v_mul_f32 v69, v69, v29
    v_mul_f32 v70, v70, v30
    v_mul_f32 v71, v71, v31
    v_cvt_pk_bf16_f32 v32, v64, v65
    v_cvt_pk_bf16_f32 v33, v66, v67
    v_cvt_pk_bf16_f32 v34, v68, v69
    v_cvt_pk_bf16_f32 v35, v70, v71
    buffer_store_dwordx4 v[32:35], v3, s[24:27], s3 offen offset:0 sc0 sc1
    v_mul_f32 v36, v80, v80
    v_mul_f32 v37, v81, v81
    v_mul_f32 v38, v82, v82
    v_mul_f32 v39, v83, v83
    v_mul_f32 v40, v84, v84
    v_mul_f32 v41, v85, v85
    v_mul_f32 v42, v86, v86
    v_mul_f32 v43, v87, v87
    v_fmamk_f32 v36, v36, 0xbdd2d3e8, v12
    v_fmamk_f32 v37, v37, 0xbdd2d3e8, v12
    v_fmamk_f32 v38, v38, 0xbdd2d3e8, v12
    v_fmamk_f32 v39, v39, 0xbdd2d3e8, v12
    v_fmamk_f32 v40, v40, 0xbdd2d3e8, v12
    v_fmamk_f32 v41, v41, 0xbdd2d3e8, v12
    v_fmamk_f32 v42, v42, 0xbdd2d3e8, v12
    v_fmamk_f32 v43, v43, 0xbdd2d3e8, v12
    v_mul_f32 v36, v36, v80
    v_mul_f32 v37, v37, v81
    v_mul_f32 v38, v38, v82
    v_mul_f32 v39, v39, v83
    v_mul_f32 v40, v40, v84
    v_mul_f32 v41, v41, v85
    v_mul_f32 v42, v42, v86
    v_mul_f32 v43, v43, v87
    v_exp_f32 v36, v36
    v_exp_f32 v37, v37
    v_exp_f32 v38, v38
    v_exp_f32 v39, v39
    v_exp_f32 v40, v40
    v_exp_f32 v41, v41
    v_exp_f32 v42, v42
    v_exp_f32 v43, v43
    v_mul_f32 v80, v80, v88
    v_mul_f32 v81, v81, v89
    v_mul_f32 v82, v82, v90
    v_mul_f32 v83, v83, v91
    v_mul_f32 v84, v84, v92
    v_mul_f32 v85, v85, v93
    v_mul_f32 v86, v86, v94
    v_mul_f32 v87, v87, v95
    v_add_f32 v36, 1.0, v36
    v_add_f32 v37, 1.0, v37
    v_add_f32 v38, 1.0, v38
    v_add_f32 v39, 1.0, v39
    v_add_f32 v40, 1.0, v40
    v_add_f32 v41, 1.0, v41
    v_add_f32 v42, 1.0, v42
    v_add_f32 v43, 1.0, v43
    v_rcp_f32 v36, v36
    v_rcp_f32 v37, v37
    v_rcp_f32 v38, v38
    v_rcp_f32 v39, v39
    v_rcp_f32 v40, v40
    v_rcp_f32 v41, v41
    v_rcp_f32 v42, v42
    v_rcp_f32 v43, v43
    s_nop 0
    v_mul_f32 v80, v80, v36
    v_mul_f32 v81, v81, v37
    v_mul_f32 v82, v82, v38
    v_mul_f32 v83, v83, v39
    v_mul_f32 v84, v84, v40
    v_mul_f32 v85, v85, v41
    v_mul_f32 v86, v86, v42
    v_mul_f32 v87, v87, v43
    v_cvt_pk_bf16_f32 v44, v80, v81
    v_cvt_pk_bf16_f32 v45, v82, v83
    v_cvt_pk_bf16_f32 v46, v84, v85
    v_cvt_pk_bf16_f32 v47, v86, v87
    buffer_store_dwordx4 v[44:47], v3, s[24:27], s3 offen offset:1024 sc0 sc1
    v_mul_f32 v24, v96, v96
    v_mul_f32 v25, v97, v97
    v_mul_f32 v26, v98, v98
    v_mul_f32 v27, v99, v99
    v_mul_f32 v28, v100, v100
    v_mul_f32 v29, v101, v101
    v_mul_f32 v30, v102, v102
    v_mul_f32 v31, v103, v103
    v_fmamk_f32 v24, v24, 0xbdd2d3e8, v12
    v_fmamk_f32 v25, v25, 0xbdd2d3e8, v12
    v_fmamk_f32 v26, v26, 0xbdd2d3e8, v12
    v_fmamk_f32 v27, v27, 0xbdd2d3e8, v12
    v_fmamk_f32 v28, v28, 0xbdd2d3e8, v12
    v_fmamk_f32 v29, v29, 0xbdd2d3e8, v12
    v_fmamk_f32 v30, v30, 0xbdd2d3e8, v12
    v_fmamk_f32 v31, v31, 0xbdd2d3e8, v12
    v_mul_f32 v24, v24, v96
    v_mul_f32 v25, v25, v97
    v_mul_f32 v26, v26, v98
    v_mul_f32 v27, v27, v99
    v_mul_f32 v28, v28, v100
    v_mul_f32 v29, v29, v101
    v_mul_f32 v30, v30, v102
    v_mul_f32 v31, v31, v103
    v_exp_f32 v24, v24
    v_exp_f32 v25, v25
    v_exp_f32 v26, v26
    v_exp_f32 v27, v27
    v_exp_f32 v28, v28
    v_exp_f32 v29, v29
    v_exp_f32 v30, v30
    v_exp_f32 v31, v31
    v_mul_f32 v96, v96, v104
    v_mul_f32 v97, v97, v105
    v_mul_f32 v98, v98, v106
    v_mul_f32 v99, v99, v107
    v_mul_f32 v100, v100, v108
    v_mul_f32 v101, v101, v109
    v_mul_f32 v102, v102, v110
    v_mul_f32 v103, v103, v111
    v_add_f32 v24, 1.0, v24
    v_add_f32 v25, 1.0, v25
    v_add_f32 v26, 1.0, v26
    v_add_f32 v27, 1.0, v27
    v_add_f32 v28, 1.0, v28
    v_add_f32 v29, 1.0, v29
    v_add_f32 v30, 1.0, v30
    v_add_f32 v31, 1.0, v31
    v_rcp_f32 v24, v24
    v_rcp_f32 v25, v25
    v_rcp_f32 v26, v26
    v_rcp_f32 v27, v27
    v_rcp_f32 v28, v28
    v_rcp_f32 v29, v29
    v_rcp_f32 v30, v30
    v_rcp_f32 v31, v31
    s_nop 0
    v_mul_f32 v96, v96, v24
    v_mul_f32 v97, v97, v25
    v_mul_f32 v98, v98, v26
    v_mul_f32 v99, v99, v27
    v_mul_f32 v100, v100, v28
    v_mul_f32 v101, v101, v29
    v_mul_f32 v102, v102, v30
    v_mul_f32 v103, v103, v31
    v_cvt_pk_bf16_f32 v32, v96, v97
    v_cvt_pk_bf16_f32 v33, v98, v99
    v_cvt_pk_bf16_f32 v34, v100, v101
    v_cvt_pk_bf16_f32 v35, v102, v103
    buffer_store_dwordx4 v[32:35], v3, s[24:27], s3 offen offset:2048 sc0 sc1
    v_mul_f32 v36, v112, v112
    v_mul_f32 v37, v113, v113
    v_mul_f32 v38, v114, v114
    v_mul_f32 v39, v115, v115
    v_mul_f32 v40, v116, v116
    v_mul_f32 v41, v117, v117
    v_mul_f32 v42, v118, v118
    v_mul_f32 v43, v119, v119
    v_fmamk_f32 v36, v36, 0xbdd2d3e8, v12
    v_fmamk_f32 v37, v37, 0xbdd2d3e8, v12
    v_fmamk_f32 v38, v38, 0xbdd2d3e8, v12
    v_fmamk_f32 v39, v39, 0xbdd2d3e8, v12
    v_fmamk_f32 v40, v40, 0xbdd2d3e8, v12
    v_fmamk_f32 v41, v41, 0xbdd2d3e8, v12
    v_fmamk_f32 v42, v42, 0xbdd2d3e8, v12
    v_fmamk_f32 v43, v43, 0xbdd2d3e8, v12
    v_mul_f32 v36, v36, v112
    v_mul_f32 v37, v37, v113
    v_mul_f32 v38, v38, v114
    v_mul_f32 v39, v39, v115
    v_mul_f32 v40, v40, v116
    v_mul_f32 v41, v41, v117
    v_mul_f32 v42, v42, v118
    v_mul_f32 v43, v43, v119
    v_exp_f32 v36, v36
    v_exp_f32 v37, v37
    v_exp_f32 v38, v38
    v_exp_f32 v39, v39
    v_exp_f32 v40, v40
    v_exp_f32 v41, v41
    v_exp_f32 v42, v42
    v_exp_f32 v43, v43
    v_mul_f32 v112, v112, v120
    v_mul_f32 v113, v113, v121
    v_mul_f32 v114, v114, v122
    v_mul_f32 v115, v115, v123
    v_mul_f32 v116, v116, v124
    v_mul_f32 v117, v117, v125
    v_mul_f32 v118, v118, v126
    v_mul_f32 v119, v119, v127
    v_add_f32 v36, 1.0, v36
    v_add_f32 v37, 1.0, v37
    v_add_f32 v38, 1.0, v38
    v_add_f32 v39, 1.0, v39
    v_add_f32 v40, 1.0, v40
    v_add_f32 v41, 1.0, v41
    v_add_f32 v42, 1.0, v42
    v_add_f32 v43, 1.0, v43
    v_rcp_f32 v36, v36
    v_rcp_f32 v37, v37
    v_rcp_f32 v38, v38
    v_rcp_f32 v39, v39
    v_rcp_f32 v40, v40
    v_rcp_f32 v41, v41
    v_rcp_f32 v42, v42
    v_rcp_f32 v43, v43
    s_nop 0
    v_mul_f32 v112, v112, v36
    v_mul_f32 v113, v113, v37
    v_mul_f32 v114, v114, v38
    v_mul_f32 v115, v115, v39
    v_mul_f32 v116, v116, v40
    v_mul_f32 v117, v117, v41
    v_mul_f32 v118, v118, v42
    v_mul_f32 v119, v119, v43
    v_cvt_pk_bf16_f32 v44, v112, v113
    v_cvt_pk_bf16_f32 v45, v114, v115
    v_cvt_pk_bf16_f32 v46, v116, v117
    v_cvt_pk_bf16_f32 v47, v118, v119
    buffer_store_dwordx4 v[44:47], v3, s[24:27], s3 offen offset:3072 sc0 sc1
    s_waitcnt vmcnt(0)
    s_mov_b64 exec, 1
    ds_add_rtn_u32 v0, v164, v1 offset:36
    s_waitcnt lgkmcnt(0)
    v_readfirstlane_b32 s37, v0
    s_mov_b64 exec, -1
    s_cmp_lg_u32 s37, 3
    s_cbranch_scc1 L_f_gf
    s_mov_b64 exec, 1
    buffer_store_dwordx2 v[166:167], v3, s[24:27], s63 offen sc0 sc1
    s_mov_b64 exec, -1
L_f_gf:
    s_setprio 2
    v_lshrrev_b32 v14, 5, v2
    v_bfe_u32 v4, v2, 2, 2
    v_and_b32 v5, 1, v2
    v_lshlrev_b32 v5, 4, v5
    v_and_b32 v6, 2, v2
    v_lshl_add_u32 v5, v6, 2, v5
    v_and_b32 v6, 16, v2
    v_lshl_add_u32 v5, v6, 1, v5
    s_and_b32 s39, s47, 2
    s_lshl_b32 s39, s39, 5
    v_add_u32 v5, s39, v5
    v_lshlrev_b32 v6, 5, v4
    v_and_b32 v6, 64, v6
    v_xor_b32 v5, v5, v6
    v_lshl_add_u32 v4, v14, 2, v4
    v_lshl_add_u32 v5, v4, 7, v5
    v_xor_b32 v6, 64, v5
    v_add_u32 v12, s56, v5
    v_add_u32 v13, s56, v6
    s_lshl2_add_u32 s40, s43, s47
    s_lshl_b32 s40, s40, 8
    s_add_u32 s40, s40, 33751040
    s_lshr_b32 s21, s43, 1
    s_lshl2_add_u32 s21, s21, s47
    s_lshl_b32 s21, s21, 9
    s_add_u32 s21, s21, 33882112
    s_add_u32 m0, s56, 8192
    s_add_u32 s37, s57, s54
    s_add_u32 s54, s54, 1
    s_cmp_eq_u32 s54, 6
    s_cselect_b32 s54, 0, s54
    s_lshl_b32 s37, s37, 15
    s_add_u32 s37, s37, s45
    s_waitcnt vmcnt(2)
    buffer_load_dwordx4 v8, s[28:31], s37 offen offset:0 lds
    buffer_load_dwordx4 v9, s[28:31], s37 offen offset:1024 lds
    buffer_load_dwordx4 v10, s[28:31], s37 offen offset:2048 lds
    buffer_load_dwordx4 v11, s[28:31], s37 offen offset:3072 lds
    s_add_u32 m0, s56, 12288
    s_add_u32 s37, s57, s54
    s_add_u32 s54, s54, 1
    s_cmp_eq_u32 s54, 6
    s_cselect_b32 s54, 0, s54
    s_lshl_b32 s37, s37, 15
    s_add_u32 s37, s37, s45
    s_waitcnt vmcnt(2)
    buffer_load_dwordx4 v8, s[28:31], s37 offen offset:0 lds
    buffer_load_dwordx4 v9, s[28:31], s37 offen offset:1024 lds
    buffer_load_dwordx4 v10, s[28:31], s37 offen offset:2048 lds
    buffer_load_dwordx4 v11, s[28:31], s37 offen offset:3072 lds
    s_mov_b32 s6, 0x200000
    s_mov_b32 s7, 0x00020000
    s_mov_b64 s[16:17], s[18:19]
    s_mov_b32 s18, 0x200000
    s_mov_b32 s19, 0x00020000
    s_and_b32 s38, s47, 1
    s_lshl1_add_u32 s37, s43, s38
    s_lshl_b32 s48, s37, 15
    s_add_u32 s48, s48, s45
    s_and_b32 s39, s47, 2
    s_lshl_b32 s39, s39, 5
    s_add_u32 s48, s48, s39
    v_and_b32 v4, 31, v2
    v_lshlrev_b32 v4, 10, v4
    v_lshl_add_u32 v4, v14, 4, v4
    buffer_load_dwordx4 v[16:19], v4, s[4:7], s48 offen
    buffer_load_dwordx4 v[20:23], v4, s[4:7], s48 offen offset:32
    v_lshlrev_b32 v6, 10, v2
    s_lshl_b32 s37, s47, 17
    s_add_u32 s37, s37, s45
    s_add_u32 s38, s37, 65536
    buffer_load_dword v7, v6, s[32:35], s37 offen
    buffer_load_dword v15, v6, s[32:35], s38 offen
    s_lshl2_add_u32 s50, s41, s47
    s_lshl_b32 s50, s50, 10
    s_add_u32 s50, s50, 33816576
    v_add_u32 v5, s56, v3
    s_xor_b32 s37, s47, 1
    s_mul_i32 s37, s37, 20480
    s_add_u32 s37, s37, 65536
    v_add_u32 v160, s37, v3
    s_xor_b32 s37, s47, 2
    s_mul_i32 s37, s37, 20480
    s_add_u32 s37, s37, 69632
    v_add_u32 v161, s37, v3
    s_xor_b32 s37, s47, 3
    s_mul_i32 s37, s37, 20480
    s_add_u32 s37, s37, 73728
    v_add_u32 v162, s37, v3
    s_mov_b32 s62, 0x20000
    s_mov_b32 exec_lo, 0x3
    s_mov_b32 exec_hi, 0
L_f_pollh:
    buffer_load_dwordx2 v[24:25], v165, s[24:27], s40 offen sc1
    s_waitcnt vmcnt(0)
    v_cmp_ne_u64 vcc, s[60:61], v[24:25]
    s_sub_u32 s62, s62, 1
    s_cbranch_scc1 L_f_pollh_ok
    s_cbranch_vccz L_f_pollh_ok
    s_sleep 2
    s_branch L_f_pollh
L_f_pollh_ok:
    s_mov_b64 exec, -1
    v_lshlrev_b32 v32, 16, v16
    v_and_b32 v33, 0xffff0000, v16
    v_lshlrev_b32 v34, 16, v17
    v_and_b32 v35, 0xffff0000, v17
    v_lshlrev_b32 v36, 16, v18
    v_and_b32 v37, 0xffff0000, v18
    v_lshlrev_b32 v38, 16, v19
    v_and_b32 v39, 0xffff0000, v19
    v_lshlrev_b32 v40, 16, v20
    v_and_b32 v41, 0xffff0000, v20
    v_lshlrev_b32 v42, 16, v21
    v_and_b32 v43, 0xffff0000, v21
    v_lshlrev_b32 v44, 16, v22
    v_and_b32 v45, 0xffff0000, v22
    v_lshlrev_b32 v46, 16, v23
    v_and_b32 v47, 0xffff0000, v23
    s_add_u32 s37, s57, s55
    s_add_u32 s55, s55, 1
    s_cmp_eq_u32 s55, 6
    s_cselect_b32 s55, 0, s55
    s_lshl_b32 s37, s37, 11
    s_add_u32 s37, s37, 32768
    s_add_u32 s38, s37, s53
    s_add_u32 s37, s37, s46
    s_waitcnt vmcnt(2)
    buffer_load_dwordx4 v[96:99], v3, s[24:27], s37 offen offset:0 sc1
    buffer_load_dwordx4 v[100:103], v3, s[24:27], s38 offen offset:0 sc1
    buffer_load_dwordx4 v[104:107], v3, s[24:27], s37 offen offset:1024 sc1
    buffer_load_dwordx4 v[108:111], v3, s[24:27], s38 offen offset:1024 sc1
    s_add_u32 s37, s57, s55
    s_add_u32 s55, s55, 1
    s_cmp_eq_u32 s55, 6
    s_cselect_b32 s55, 0, s55
    s_lshl_b32 s37, s37, 11
    s_add_u32 s37, s37, 32768
    s_add_u32 s38, s37, s53
    s_add_u32 s37, s37, s46
    s_waitcnt vmcnt(2)
    buffer_load_dwordx4 v[112:115], v3, s[24:27], s37 offen offset:0 sc1
    buffer_load_dwordx4 v[116:119], v3, s[24:27], s38 offen offset:0 sc1
    buffer_load_dwordx4 v[120:123], v3, s[24:27], s37 offen offset:1024 sc1
    buffer_load_dwordx4 v[124:127], v3, s[24:27], s38 offen offset:1024 sc1
    s_add_u32 s37, s57, s55
    s_add_u32 s55, s55, 1
    s_cmp_eq_u32 s55, 6
    s_cselect_b32 s55, 0, s55
    s_lshl_b32 s37, s37, 11
    s_add_u32 s37, s37, 32768
    s_add_u32 s38, s37, s53
    s_add_u32 s37, s37, s46
    s_waitcnt vmcnt(2)
    buffer_load_dwordx4 v[128:131], v3, s[24:27], s37 offen offset:0 sc1
    buffer_load_dwordx4 v[132:135], v3, s[24:27], s38 offen offset:0 sc1
    buffer_load_dwordx4 v[136:139], v3, s[24:27], s37 offen offset:1024 sc1
    buffer_load_dwordx4 v[140:143], v3, s[24:27], s38 offen offset:1024 sc1
    s_add_u32 s37, s57, s55
    s_add_u32 s55, s55, 1
    s_cmp_eq_u32 s55, 6
    s_cselect_b32 s55, 0, s55
    s_lshl_b32 s37, s37, 11
    s_add_u32 s37, s37, 32768
    s_add_u32 s38, s37, s53
    s_add_u32 s37, s37, s46
    s_waitcnt vmcnt(2)
    buffer_load_dwordx4 v[144:147], v3, s[24:27], s37 offen offset:0 sc1
    buffer_load_dwordx4 v[148:151], v3, s[24:27], s38 offen offset:0 sc1
    buffer_load_dwordx4 v[152:155], v3, s[24:27], s37 offen offset:1024 sc1
    buffer_load_dwordx4 v[156:159], v3, s[24:27], s38 offen offset:1024 sc1
    s_add_u32 m0, s56, 16384
    s_add_u32 s37, s57, s54
    s_add_u32 s54, s54, 1
    s_cmp_eq_u32 s54, 6
    s_cselect_b32 s54, 0, s54
    s_lshl_b32 s37, s37, 15
    s_add_u32 s37, s37, s45
    s_waitcnt vmcnt(2)
    buffer_load_dwordx4 v8, s[28:31], s37 offen offset:0 lds
    buffer_load_dwordx4 v9, s[28:31], s37 offen offset:1024 lds
    buffer_load_dwordx4 v10, s[28:31], s37 offen offset:2048 lds
    buffer_load_dwordx4 v11, s[28:31], s37 offen offset:3072 lds
    s_waitcnt vmcnt(16)
    ds_read_b64_tr_b16 v[16:17], v12 offset:0
    ds_read_b64_tr_b16 v[18:19], v12 offset:1024
    ds_read_b64_tr_b16 v[20:21], v13 offset:0
    ds_read_b64_tr_b16 v[22:23], v13 offset:1024
    ds_read_b64_tr_b16 v[24:25], v12 offset:2048
    ds_read_b64_tr_b16 v[26:27], v12 offset:3072
    ds_read_b64_tr_b16 v[28:29], v13 offset:2048
    ds_read_b64_tr_b16 v[30:31], v13 offset:3072
    s_waitcnt lgkmcnt(4)
    s_setprio 0
    v_mfma_f32_32x32x16_bf16 v[32:47], v[16:19], v[96:99], v[32:47]
    s_setprio 2
    s_setprio 0
    v_mfma_f32_32x32x16_bf16 v[48:63], v[16:19], v[100:103], 0
    s_setprio 2
    s_setprio 0
    v_mfma_f32_32x32x16_bf16 v[64:79], v[20:23], v[96:99], 0
    s_setprio 2
    s_setprio 0
    v_mfma_f32_32x32x16_bf16 v[80:95], v[20:23], v[100:103], 0
    s_setprio 2
    s_waitcnt lgkmcnt(0)
    s_setprio 0
    v_mfma_f32_32x32x16_bf16 v[32:47], v[24:27], v[104:107], v[32:47]
    s_setprio 2
    s_setprio 0
    v_mfma_f32_32x32x16_bf16 v[48:63], v[24:27], v[108:111], v[48:63]
    s_setprio 2
    s_setprio 0
    v_mfma_f32_32x32x16_bf16 v[64:79], v[28:31], v[104:107], v[64:79]
    s_setprio 2
    s_setprio 0
    v_mfma_f32_32x32x16_bf16 v[80:95], v[28:31], v[108:111], v[80:95]
    s_setprio 2
    s_add_u32 s37, s57, s55
    s_add_u32 s55, s55, 1
    s_cmp_eq_u32 s55, 6
    s_cselect_b32 s55, 0, s55
    s_lshl_b32 s37, s37, 11
    s_add_u32 s37, s37, 32768
    s_add_u32 s38, s37, s53
    s_add_u32 s37, s37, s46
    s_waitcnt vmcnt(2)
    buffer_load_dwordx4 v[96:99], v3, s[24:27], s37 offen offset:0 sc1
    buffer_load_dwordx4 v[100:103], v3, s[24:27], s38 offen offset:0 sc1
    buffer_load_dwordx4 v[104:107], v3, s[24:27], s37 offen offset:1024 sc1
    buffer_load_dwordx4 v[108:111], v3, s[24:27], s38 offen offset:1024 sc1
    s_add_u32 m0, s56, 0
    s_add_u32 s37, s57, s54
    s_add_u32 s54, s54, 1
    s_cmp_eq_u32 s54, 6
    s_cselect_b32 s54, 0, s54
    s_lshl_b32 s37, s37, 15
    s_add_u32 s37, s37, s45
    s_waitcnt vmcnt(2)
    buffer_load_dwordx4 v8, s[28:31], s37 offen offset:0 lds
    buffer_load_dwordx4 v9, s[28:31], s37 offen offset:1024 lds
    buffer_load_dwordx4 v10, s[28:31], s37 offen offset:2048 lds
    buffer_load_dwordx4 v11, s[28:31], s37 offen offset:3072 lds
    s_waitcnt vmcnt(20)
    ds_read_b64_tr_b16 v[16:17], v12 offset:4096
    ds_read_b64_tr_b16 v[18:19], v12 offset:5120
    ds_read_b64_tr_b16 v[20:21], v13 offset:4096
    ds_read_b64_tr_b16 v[22:23], v13 offset:5120
    ds_read_b64_tr_b16 v[24:25], v12 offset:6144
    ds_read_b64_tr_b16 v[26:27], v12 offset:7168
    ds_read_b64_tr_b16 v[28:29], v13 offset:6144
    ds_read_b64_tr_b16 v[30:31], v13 offset:7168
    s_waitcnt lgkmcnt(4)
    s_setprio 0
    v_mfma_f32_32x32x16_bf16 v[32:47], v[16:19], v[112:115], v[32:47]
    s_setprio 2
    s_setprio 0
    v_mfma_f32_32x32x16_bf16 v[48:63], v[16:19], v[116:119], v[48:63]
    s_setprio 2
    s_setprio 0
    v_mfma_f32_32x32x16_bf16 v[64:79], v[20:23], v[112:115], v[64:79]
    s_setprio 2
    s_setprio 0
    v_mfma_f32_32x32x16_bf16 v[80:95], v[20:23], v[116:119], v[80:95]
    s_setprio 2
    s_waitcnt lgkmcnt(0)
    s_setprio 0
    v_mfma_f32_32x32x16_bf16 v[32:47], v[24:27], v[120:123], v[32:47]
    s_setprio 2
    s_setprio 0
    v_mfma_f32_32x32x16_bf16 v[48:63], v[24:27], v[124:127], v[48:63]
    s_setprio 2
    s_setprio 0
    v_mfma_f32_32x32x16_bf16 v[64:79], v[28:31], v[120:123], v[64:79]
    s_setprio 2
    s_setprio 0
    v_mfma_f32_32x32x16_bf16 v[80:95], v[28:31], v[124:127], v[80:95]
    s_setprio 2
    s_add_u32 s37, s57, s55
    s_add_u32 s55, s55, 1
    s_cmp_eq_u32 s55, 6
    s_cselect_b32 s55, 0, s55
    s_lshl_b32 s37, s37, 11
    s_add_u32 s37, s37, 32768
    s_add_u32 s38, s37, s53
    s_add_u32 s37, s37, s46
    s_waitcnt vmcnt(2)
    buffer_load_dwordx4 v[112:115], v3, s[24:27], s37 offen offset:0 sc1
    buffer_load_dwordx4 v[116:119], v3, s[24:27], s38 offen offset:0 sc1
    buffer_load_dwordx4 v[120:123], v3, s[24:27], s37 offen offset:1024 sc1
    buffer_load_dwordx4 v[124:127], v3, s[24:27], s38 offen offset:1024 sc1
    s_add_u32 m0, s56, 4096
    s_mov_b32 s54, s20
    s_add_u32 s37, s58, s54
    s_add_u32 s54, s54, 1
    s_and_b32 s54, s54, 7
    s_lshl_b32 s37, s37, 15
    s_add_u32 s37, s37, s45
    s_waitcnt vmcnt(2)
    buffer_load_dwordx4 v8, s[28:31], s37 offen offset:0 lds
    buffer_load_dwordx4 v9, s[28:31], s37 offen offset:1024 lds
    buffer_load_dwordx4 v10, s[28:31], s37 offen offset:2048 lds
    buffer_load_dwordx4 v11, s[28:31], s37 offen offset:3072 lds
    s_waitcnt vmcnt(24)
    ds_read_b64_tr_b16 v[16:17], v12 offset:8192
    ds_read_b64_tr_b16 v[18:19], v12 offset:9216
    ds_read_b64_tr_b16 v[20:21], v13 offset:8192
    ds_read_b64_tr_b16 v[22:23], v13 offset:9216
    ds_read_b64_tr_b16 v[24:25], v12 offset:10240
    ds_read_b64_tr_b16 v[26:27], v12 offset:11264
    ds_read_b64_tr_b16 v[28:29], v13 offset:10240
    ds_read_b64_tr_b16 v[30:31], v13 offset:11264
    s_waitcnt lgkmcnt(4)
    s_setprio 0
    v_mfma_f32_32x32x16_bf16 v[32:47], v[16:19], v[128:131], v[32:47]
    s_setprio 2
    s_setprio 0
    v_mfma_f32_32x32x16_bf16 v[48:63], v[16:19], v[132:135], v[48:63]
    s_setprio 2
    s_setprio 0
    v_mfma_f32_32x32x16_bf16 v[64:79], v[20:23], v[128:131], v[64:79]
    s_setprio 2
    s_setprio 0
    v_mfma_f32_32x32x16_bf16 v[80:95], v[20:23], v[132:135], v[80:95]
    s_setprio 2
    s_waitcnt lgkmcnt(0)
    s_setprio 0
    v_mfma_f32_32x32x16_bf16 v[32:47], v[24:27], v[136:139], v[32:47]
    s_setprio 2
    s_setprio 0
    v_mfma_f32_32x32x16_bf16 v[48:63], v[24:27], v[140:143], v[48:63]
    s_setprio 2
    s_setprio 0
    v_mfma_f32_32x32x16_bf16 v[64:79], v[28:31], v[136:139], v[64:79]
    s_setprio 2
    s_setprio 0
    v_mfma_f32_32x32x16_bf16 v[80:95], v[28:31], v[140:143], v[80:95]
    s_setprio 2
    s_mov_b32 s62, 0x20000
    s_mov_b32 exec_lo, 0xf
    s_mov_b32 exec_hi, 0
L_f_pollg:
    buffer_load_dwordx2 v[16:17], v165, s[24:27], s21 offen sc1
    s_waitcnt vmcnt(0)
    v_cmp_ne_u64 vcc, s[60:61], v[16:17]
    s_sub_u32 s62, s62, 1
    s_cbranch_scc1 L_f_pollg_ok
    s_cbranch_vccz L_f_pollg_ok
    s_sleep 2
    s_branch L_f_pollg
L_f_pollg_ok:
    s_mov_b64 exec, -1
    s_mov_b32 s55, s20
    s_add_u32 s37, s58, s55
    s_add_u32 s55, s55, 1
    s_and_b32 s55, s55, 7
    s_lshl_b32 s37, s37, 11
    s_add_u32 s37, s37, 32768
    s_add_u32 s38, s37, s53
    s_add_u32 s37, s37, s46
    s_waitcnt vmcnt(2)
    buffer_load_dwordx4 v[128:131], v3, s[24:27], s37 offen offset:0 sc1
    buffer_load_dwordx4 v[132:135], v3, s[24:27], s38 offen offset:0 sc1
    buffer_load_dwordx4 v[136:139], v3, s[24:27], s37 offen offset:1024 sc1
    buffer_load_dwordx4 v[140:143], v3, s[24:27], s38 offen offset:1024 sc1
    s_add_u32 m0, s56, 8192
    s_add_u32 s37, s58, s54
    s_add_u32 s54, s54, 1
    s_and_b32 s54, s54, 7
    s_lshl_b32 s37, s37, 15
    s_add_u32 s37, s37, s45
    s_waitcnt vmcnt(2)
    buffer_load_dwordx4 v8, s[28:31], s37 offen offset:0 lds
    buffer_load_dwordx4 v9, s[28:31], s37 offen offset:1024 lds
    buffer_load_dwordx4 v10, s[28:31], s37 offen offset:2048 lds
    buffer_load_dwordx4 v11, s[28:31], s37 offen offset:3072 lds
    ds_read_b64_tr_b16 v[16:17], v12 offset:12288
    ds_read_b64_tr_b16 v[18:19], v12 offset:13312
    ds_read_b64_tr_b16 v[20:21], v13 offset:12288
    ds_read_b64_tr_b16 v[22:23], v13 offset:13312
    ds_read_b64_tr_b16 v[24:25], v12 offset:14336
    ds_read_b64_tr_b16 v[26:27], v12 offset:15360
    ds_read_b64_tr_b16 v[28:29], v13 offset:14336
    ds_read_b64_tr_b16 v[30:31], v13 offset:15360
    s_waitcnt lgkmcnt(4)
    s_setprio 0
    v_mfma_f32_32x32x16_bf16 v[32:47], v[16:19], v[144:147], v[32:47]
    s_setprio 2
    s_setprio 0
    v_mfma_f32_32x32x16_bf16 v[48:63], v[16:19], v[148:151], v[48:63]
    s_setprio 2
    s_setprio 0
    v_mfma_f32_32x32x16_bf16 v[64:79], v[20:23], v[144:147], v[64:79]
    s_setprio 2
    s_setprio 0
    v_mfma_f32_32x32x16_bf16 v[80:95], v[20:23], v[148:151], v[80:95]
    s_setprio 2
    s_waitcnt lgkmcnt(0)
    s_setprio 0
    v_mfma_f32_32x32x16_bf16 v[32:47], v[24:27], v[152:155], v[32:47]
    s_setprio 2
    s_setprio 0
    v_mfma_f32_32x32x16_bf16 v[48:63], v[24:27], v[156:159], v[48:63]
    s_setprio 2
    s_setprio 0
    v_mfma_f32_32x32x16_bf16 v[64:79], v[28:31], v[152:155], v[64:79]
    s_setprio 2
    s_setprio 0
    v_mfma_f32_32x32x16_bf16 v[80:95], v[28:31], v[156:159], v[80:95]
    s_setprio 2
    s_add_u32 s37, s58, s55
    s_add_u32 s55, s55, 1
    s_and_b32 s55, s55, 7
    s_lshl_b32 s37, s37, 11
    s_add_u32 s37, s37, 32768
    s_add_u32 s38, s37, s53
    s_add_u32 s37, s37, s46
    s_waitcnt vmcnt(2)
    buffer_load_dwordx4 v[144:147], v3, s[24:27], s37 offen offset:0 sc1
    buffer_load_dwordx4 v[148:151], v3, s[24:27], s38 offen offset:0 sc1
    buffer_load_dwordx4 v[152:155], v3, s[24:27], s37 offen offset:1024 sc1
    buffer_load_dwordx4 v[156:159], v3, s[24:27], s38 offen offset:1024 sc1
    s_add_u32 m0, s56, 12288
    s_add_u32 s37, s58, s54
    s_add_u32 s54, s54, 1
    s_and_b32 s54, s54, 7
    s_lshl_b32 s37, s37, 15
    s_add_u32 s37, s37, s45
    s_waitcnt vmcnt(2)
    buffer_load_dwordx4 v8, s[28:31], s37 offen offset:0 lds
    buffer_load_dwordx4 v9, s[28:31], s37 offen offset:1024 lds
    buffer_load_dwordx4 v10, s[28:31], s37 offen offset:2048 lds
    buffer_load_dwordx4 v11, s[28:31], s37 offen offset:3072 lds
    ds_read_b64_tr_b16 v[16:17], v12 offset:16384
    ds_read_b64_tr_b16 v[18:19], v12 offset:17408
    ds_read_b64_tr_b16 v[20:21], v13 offset:16384
    ds_read_b64_tr_b16 v[22:23], v13 offset:17408
    ds_read_b64_tr_b16 v[24:25], v12 offset:18432
    ds_read_b64_tr_b16 v[26:27], v12 offset:19456
    ds_read_b64_tr_b16 v[28:29], v13 offset:18432
    ds_read_b64_tr_b16 v[30:31], v13 offset:19456
    s_waitcnt lgkmcnt(4)
    s_setprio 0
    v_mfma_f32_32x32x16_bf16 v[32:47], v[16:19], v[96:99], v[32:47]
    s_setprio 2
    s_setprio 0
    v_mfma_f32_32x32x16_bf16 v[48:63], v[16:19], v[100:103], v[48:63]
    s_setprio 2
    s_setprio 0
    v_mfma_f32_32x32x16_bf16 v[64:79], v[20:23], v[96:99], v[64:79]
    s_setprio 2
    s_setprio 0
    v_mfma_f32_32x32x16_bf16 v[80:95], v[20:23], v[100:103], v[80:95]
    s_setprio 2
    s_waitcnt lgkmcnt(0)
    s_setprio 0
    v_mfma_f32_32x32x16_bf16 v[32:47], v[24:27], v[104:107], v[32:47]
    s_setprio 2
    s_setprio 0
    v_mfma_f32_32x32x16_bf16 v[48:63], v[24:27], v[108:111], v[48:63]
    s_setprio 2
    s_setprio 0
    v_mfma_f32_32x32x16_bf16 v[64:79], v[28:31], v[104:107], v[64:79]
    s_setprio 2
    s_setprio 0
    v_mfma_f32_32x32x16_bf16 v[80:95], v[28:31], v[108:111], v[80:95]
    s_setprio 2
    s_add_u32 s37, s58, s55
    s_add_u32 s55, s55, 1
    s_and_b32 s55, s55, 7
    s_lshl_b32 s37, s37, 11
    s_add_u32 s37, s37, 32768
    s_add_u32 s38, s37, s53
    s_add_u32 s37, s37, s46
    s_waitcnt vmcnt(2)
    buffer_load_dwordx4 v[96:99], v3, s[24:27], s37 offen offset:0 sc1
    buffer_load_dwordx4 v[100:103], v3, s[24:27], s38 offen offset:0 sc1
    buffer_load_dwordx4 v[104:107], v3, s[24:27], s37 offen offset:1024 sc1
    buffer_load_dwordx4 v[108:111], v3, s[24:27], s38 offen offset:1024 sc1
    s_add_u32 m0, s56, 16384
    s_add_u32 s37, s58, s54
    s_add_u32 s54, s54, 1
    s_and_b32 s54, s54, 7
    s_lshl_b32 s37, s37, 15
    s_add_u32 s37, s37, s45
    s_waitcnt vmcnt(2)
    buffer_load_dwordx4 v8, s[28:31], s37 offen offset:0 lds
    buffer_load_dwordx4 v9, s[28:31], s37 offen offset:1024 lds
    buffer_load_dwordx4 v10, s[28:31], s37 offen offset:2048 lds
    buffer_load_dwordx4 v11, s[28:31], s37 offen offset:3072 lds
    ds_read_b64_tr_b16 v[16:17], v12 offset:0
    ds_read_b64_tr_b16 v[18:19], v12 offset:1024
    ds_read_b64_tr_b16 v[20:21], v13 offset:0
    ds_read_b64_tr_b16 v[22:23], v13 offset:1024
    ds_read_b64_tr_b16 v[24:25], v12 offset:2048
    ds_read_b64_tr_b16 v[26:27], v12 offset:3072
    ds_read_b64_tr_b16 v[28:29], v13 offset:2048
    ds_read_b64_tr_b16 v[30:31], v13 offset:3072
    s_waitcnt lgkmcnt(4)
    s_setprio 0
    v_mfma_f32_32x32x16_bf16 v[32:47], v[16:19], v[112:115], v[32:47]
    s_setprio 2
    s_setprio 0
    v_mfma_f32_32x32x16_bf16 v[48:63], v[16:19], v[116:119], v[48:63]
    s_setprio 2
    s_setprio 0
    v_mfma_f32_32x32x16_bf16 v[64:79], v[20:23], v[112:115], v[64:79]
    s_setprio 2
    s_setprio 0
    v_mfma_f32_32x32x16_bf16 v[80:95], v[20:23], v[116:119], v[80:95]
    s_setprio 2
    s_waitcnt lgkmcnt(0)
    s_setprio 0
    v_mfma_f32_32x32x16_bf16 v[32:47], v[24:27], v[120:123], v[32:47]
    s_setprio 2
    s_setprio 0
    v_mfma_f32_32x32x16_bf16 v[48:63], v[24:27], v[124:127], v[48:63]
    s_setprio 2
    s_setprio 0
    v_mfma_f32_32x32x16_bf16 v[64:79], v[28:31], v[120:123], v[64:79]
    s_setprio 2
    s_setprio 0
    v_mfma_f32_32x32x16_bf16 v[80:95], v[28:31], v[124:127], v[80:95]
    s_setprio 2
    s_add_u32 s37, s58, s55
    s_add_u32 s55, s55, 1
    s_and_b32 s55, s55, 7
    s_lshl_b32 s37, s37, 11
    s_add_u32 s37, s37, 32768
    s_add_u32 s38, s37, s53
    s_add_u32 s37, s37, s46
    s_waitcnt vmcnt(2)
    buffer_load_dwordx4 v[112:115], v3, s[24:27], s37 offen offset:0 sc1
    buffer_load_dwordx4 v[116:119], v3, s[24:27], s38 offen offset:0 sc1
    buffer_load_dwordx4 v[120:123], v3, s[24:27], s37 offen offset:1024 sc1
    buffer_load_dwordx4 v[124:127], v3, s[24:27], s38 offen offset:1024 sc1
    s_add_u32 m0, s56, 0
    s_add_u32 s37, s58, s54
    s_add_u32 s54, s54, 1
    s_and_b32 s54, s54, 7
    s_lshl_b32 s37, s37, 15
    s_add_u32 s37, s37, s45
    s_waitcnt vmcnt(2)
    buffer_load_dwordx4 v8, s[28:31], s37 offen offset:0 lds
    buffer_load_dwordx4 v9, s[28:31], s37 offen offset:1024 lds
    buffer_load_dwordx4 v10, s[28:31], s37 offen offset:2048 lds
    buffer_load_dwordx4 v11, s[28:31], s37 offen offset:3072 lds
    s_waitcnt vmcnt(28)
    ds_read_b64_tr_b16 v[16:17], v12 offset:4096
    ds_read_b64_tr_b16 v[18:19], v12 offset:5120
    ds_read_b64_tr_b16 v[20:21], v13 offset:4096
    ds_read_b64_tr_b16 v[22:23], v13 offset:5120
    ds_read_b64_tr_b16 v[24:25], v12 offset:6144
    ds_read_b64_tr_b16 v[26:27], v12 offset:7168
    ds_read_b64_tr_b16 v[28:29], v13 offset:6144
    ds_read_b64_tr_b16 v[30:31], v13 offset:7168
    s_waitcnt lgkmcnt(4)
    s_setprio 0
    v_mfma_f32_32x32x16_bf16 v[32:47], v[16:19], v[128:131], v[32:47]
    s_setprio 2
    s_setprio 0
    v_mfma_f32_32x32x16_bf16 v[48:63], v[16:19], v[132:135], v[48:63]
    s_setprio 2
    s_setprio 0
    v_mfma_f32_32x32x16_bf16 v[64:79], v[20:23], v[128:131], v[64:79]
    s_setprio 2
    s_setprio 0
    v_mfma_f32_32x32x16_bf16 v[80:95], v[20:23], v[132:135], v[80:95]
    s_setprio 2
    s_waitcnt lgkmcnt(0)
    s_setprio 0
    v_mfma_f32_32x32x16_bf16 v[32:47], v[24:27], v[136:139], v[32:47]
    s_setprio 2
    s_setprio 0
    v_mfma_f32_32x32x16_bf16 v[48:63], v[24:27], v[140:143], v[48:63]
    s_setprio 2
    s_setprio 0
    v_mfma_f32_32x32x16_bf16 v[64:79], v[28:31], v[136:139], v[64:79]
    s_setprio 2
    s_setprio 0
    v_mfma_f32_32x32x16_bf16 v[80:95], v[28:31], v[140:143], v[80:95]
    s_setprio 2
    s_add_u32 s37, s58, s55
    s_add_u32 s55, s55, 1
    s_and_b32 s55, s55, 7
    s_lshl_b32 s37, s37, 11
    s_add_u32 s37, s37, 32768
    s_add_u32 s38, s37, s53
    s_add_u32 s37, s37, s46
    s_waitcnt vmcnt(2)
    buffer_load_dwordx4 v[128:131], v3, s[24:27], s37 offen offset:0 sc1
    buffer_load_dwordx4 v[132:135], v3, s[24:27], s38 offen offset:0 sc1
    buffer_load_dwordx4 v[136:139], v3, s[24:27], s37 offen offset:1024 sc1
    buffer_load_dwordx4 v[140:143], v3, s[24:27], s38 offen offset:1024 sc1
    s_add_u32 m0, s56, 4096
    s_add_u32 s37, s58, s54
    s_add_u32 s54, s54, 1
    s_and_b32 s54, s54, 7
    s_lshl_b32 s37, s37, 15
    s_add_u32 s37, s37, s45
    s_waitcnt vmcnt(2)
    buffer_load_dwordx4 v8, s[28:31], s37 offen offset:0 lds
    buffer_load_dwordx4 v9, s[28:31], s37 offen offset:1024 lds
    buffer_load_dwordx4 v10, s[28:31], s37 offen offset:2048 lds
    buffer_load_dwordx4 v11, s[28:31], s37 offen offset:3072 lds
    s_waitcnt vmcnt(28)
    ds_read_b64_tr_b16 v[16:17], v12 offset:8192
    ds_read_b64_tr_b16 v[18:19], v12 offset:9216
    ds_read_b64_tr_b16 v[20:21], v13 offset:8192
    ds_read_b64_tr_b16 v[22:23], v13 offset:9216
    ds_read_b64_tr_b16 v[24:25], v12 offset:10240
    ds_read_b64_tr_b16 v[26:27], v12 offset:11264
    ds_read_b64_tr_b16 v[28:29], v13 offset:10240
    ds_read_b64_tr_b16 v[30:31], v13 offset:11264
    s_waitcnt lgkmcnt(4)
    s_setprio 0
    v_mfma_f32_32x32x16_bf16 v[32:47], v[16:19], v[144:147], v[32:47]
    s_setprio 2
    s_setprio 0
    v_mfma_f32_32x32x16_bf16 v[48:63], v[16:19], v[148:151], v[48:63]
    s_setprio 2
    s_setprio 0
    v_mfma_f32_32x32x16_bf16 v[64:79], v[20:23], v[144:147], v[64:79]
    s_setprio 2
    s_setprio 0
    v_mfma_f32_32x32x16_bf16 v[80:95], v[20:23], v[148:151], v[80:95]
    s_setprio 2
    s_waitcnt lgkmcnt(0)
    s_setprio 0
    v_mfma_f32_32x32x16_bf16 v[32:47], v[24:27], v[152:155], v[32:47]
    s_setprio 2
    s_setprio 0
    v_mfma_f32_32x32x16_bf16 v[48:63], v[24:27], v[156:159], v[48:63]
    s_setprio 2
    s_setprio 0
    v_mfma_f32_32x32x16_bf16 v[64:79], v[28:31], v[152:155], v[64:79]
    s_setprio 2
    s_setprio 0
    v_mfma_f32_32x32x16_bf16 v[80:95], v[28:31], v[156:159], v[80:95]
    s_setprio 2
    s_add_u32 s37, s58, s55
    s_add_u32 s55, s55, 1
    s_and_b32 s55, s55, 7
    s_lshl_b32 s37, s37, 11
    s_add_u32 s37, s37, 32768
    s_add_u32 s38, s37, s53
    s_add_u32 s37, s37, s46
    s_waitcnt vmcnt(2)
    buffer_load_dwordx4 v[144:147], v3, s[24:27], s37 offen offset:0 sc1
    buffer_load_dwordx4 v[148:151], v3, s[24:27], s38 offen offset:0 sc1
    buffer_load_dwordx4 v[152:155], v3, s[24:27], s37 offen offset:1024 sc1
    buffer_load_dwordx4 v[156:159], v3, s[24:27], s38 offen offset:1024 sc1
    s_add_u32 m0, s56, 8192
    s_add_u32 s37, s58, s54
    s_add_u32 s54, s54, 1
    s_and_b32 s54, s54, 7
    s_lshl_b32 s37, s37, 15
    s_add_u32 s37, s37, s45
    s_waitcnt vmcnt(2)
    buffer_load_dwordx4 v8, s[28:31], s37 offen offset:0 lds
    buffer_load_dwordx4 v9, s[28:31], s37 offen offset:1024 lds
    buffer_load_dwordx4 v10, s[28:31], s37 offen offset:2048 lds
    buffer_load_dwordx4 v11, s[28:31], s37 offen offset:3072 lds
    s_waitcnt vmcnt(28)
    ds_read_b64_tr_b16 v[16:17], v12 offset:12288
    ds_read_b64_tr_b16 v[18:19], v12 offset:13312
    ds_read_b64_tr_b16 v[20:21], v13 offset:12288
    ds_read_b64_tr_b16 v[22:23], v13 offset:13312
    ds_read_b64_tr_b16 v[24:25], v12 offset:14336
    ds_read_b64_tr_b16 v[26:27], v12 offset:15360
    ds_read_b64_tr_b16 v[28:29], v13 offset:14336
    ds_read_b64_tr_b16 v[30:31], v13 offset:15360
    s_waitcnt lgkmcnt(4)
    s_setprio 0
    v_mfma_f32_32x32x16_bf16 v[32:47], v[16:19], v[96:99], v[32:47]
    s_setprio 2
    s_setprio 0
    v_mfma_f32_32x32x16_bf16 v[48:63], v[16:19], v[100:103], v[48:63]
    s_setprio 2
    s_setprio 0
    v_mfma_f32_32x32x16_bf16 v[64:79], v[20:23], v[96:99], v[64:79]
    s_setprio 2
    s_setprio 0
    v_mfma_f32_32x32x16_bf16 v[80:95], v[20:23], v[100:103], v[80:95]
    s_setprio 2
    s_waitcnt lgkmcnt(0)
    s_setprio 0
    v_mfma_f32_32x32x16_bf16 v[32:47], v[24:27], v[104:107], v[32:47]
    s_setprio 2
    s_setprio 0
    v_mfma_f32_32x32x16_bf16 v[48:63], v[24:27], v[108:111], v[48:63]
    s_setprio 2
    s_setprio 0
    v_mfma_f32_32x32x16_bf16 v[64:79], v[28:31], v[104:107], v[64:79]
    s_setprio 2
    s_setprio 0
    v_mfma_f32_32x32x16_bf16 v[80:95], v[28:31], v[108:111], v[80:95]
    s_setprio 2
    s_add_u32 s37, s58, s55
    s_add_u32 s55, s55, 1
    s_and_b32 s55, s55, 7
    s_lshl_b32 s37, s37, 11
    s_add_u32 s37, s37, 32768
    s_add_u32 s38, s37, s53
    s_add_u32 s37, s37, s46
    s_waitcnt vmcnt(2)
    buffer_load_dwordx4 v[96:99], v3, s[24:27], s37 offen offset:0 sc1
    buffer_load_dwordx4 v[100:103], v3, s[24:27], s38 offen offset:0 sc1
    buffer_load_dwordx4 v[104:107], v3, s[24:27], s37 offen offset:1024 sc1
    buffer_load_dwordx4 v[108:111], v3, s[24:27], s38 offen offset:1024 sc1
    s_add_u32 m0, s56, 12288
    s_add_u32 s37, s58, s54
    s_add_u32 s54, s54, 1
    s_and_b32 s54, s54, 7
    s_lshl_b32 s37, s37, 15
    s_add_u32 s37, s37, s45
    s_waitcnt vmcnt(2)
    buffer_load_dwordx4 v8, s[28:31], s37 offen offset:0 lds
    buffer_load_dwordx4 v9, s[28:31], s37 offen offset:1024 lds
    buffer_load_dwordx4 v10, s[28:31], s37 offen offset:2048 lds
    buffer_load_dwordx4 v11, s[28:31], s37 offen offset:3072 lds
    s_waitcnt vmcnt(28)
    ds_read_b64_tr_b16 v[16:17], v12 offset:16384
    ds_read_b64_tr_b16 v[18:19], v12 offset:17408
    ds_read_b64_tr_b16 v[20:21], v13 offset:16384
    ds_read_b64_tr_b16 v[22:23], v13 offset:17408
    ds_read_b64_tr_b16 v[24:25], v12 offset:18432
    ds_read_b64_tr_b16 v[26:27], v12 offset:19456
    ds_read_b64_tr_b16 v[28:29], v13 offset:18432
    ds_read_b64_tr_b16 v[30:31], v13 offset:19456
    s_waitcnt lgkmcnt(4)
    s_setprio 0
    v_mfma_f32_32x32x16_bf16 v[32:47], v[16:19], v[112:115], v[32:47]
    s_setprio 2
    s_setprio 0
    v_mfma_f32_32x32x16_bf16 v[48:63], v[16:19], v[116:119], v[48:63]
    s_setprio 2
    s_setprio 0
    v_mfma_f32_32x32x16_bf16 v[64:79], v[20:23], v[112:115], v[64:79]
    s_setprio 2
    s_setprio 0
    v_mfma_f32_32x32x16_bf16 v[80:95], v[20:23], v[116:119], v[80:95]
    s_setprio 2
    s_waitcnt lgkmcnt(0)
    s_setprio 0
    v_mfma_f32_32x32x16_bf16 v[32:47], v[24:27], v[120:123], v[32:47]
    s_setprio 2
    s_setprio 0
    v_mfma_f32_32x32x16_bf16 v[48:63], v[24:27], v[124:127], v[48:63]
    s_setprio 2
    s_setprio 0
    v_mfma_f32_32x32x16_bf16 v[64:79], v[28:31], v[120:123], v[64:79]
    s_setprio 2
    s_setprio 0
    v_mfma_f32_32x32x16_bf16 v[80:95], v[28:31], v[124:127], v[80:95]
    s_setprio 2
    s_add_u32 s37, s58, s55
    s_add_u32 s55, s55, 1
    s_and_b32 s55, s55, 7
    s_lshl_b32 s37, s37, 11
    s_add_u32 s37, s37, 32768
    s_add_u32 s38, s37, s53
    s_add_u32 s37, s37, s46
    s_waitcnt vmcnt(2)
    buffer_load_dwordx4 v[112:115], v3, s[24:27], s37 offen offset:0 sc1
    buffer_load_dwordx4 v[116:119], v3, s[24:27], s38 offen offset:0 sc1
    buffer_load_dwordx4 v[120:123], v3, s[24:27], s37 offen offset:1024 sc1
    buffer_load_dwordx4 v[124:127], v3, s[24:27], s38 offen offset:1024 sc1
    s_add_u32 m0, s56, 16384
    s_lshl_b32 s37, s47, 17
    s_add_u32 s37, s37, 0
    s_add_u32 s37, s37, s45
    s_waitcnt vmcnt(2)
    buffer_load_dwordx4 v8, s[32:35], s37 offen offset:0 lds
    buffer_load_dwordx4 v9, s[32:35], s37 offen offset:1024 lds
    buffer_load_dwordx4 v10, s[32:35], s37 offen offset:2048 lds
    buffer_load_dwordx4 v11, s[32:35], s37 offen offset:3072 lds
    s_waitcnt vmcnt(28)
    ds_read_b64_tr_b16 v[16:17], v12 offset:0
    ds_read_b64_tr_b16 v[18:19], v12 offset:1024
    ds_read_b64_tr_b16 v[20:21], v13 offset:0
    ds_read_b64_tr_b16 v[22:23], v13 offset:1024
    ds_read_b64_tr_b16 v[24:25], v12 offset:2048
    ds_read_b64_tr_b16 v[26:27], v12 offset:3072
    ds_read_b64_tr_b16 v[28:29], v13 offset:2048
    ds_read_b64_tr_b16 v[30:31], v13 offset:3072
    s_waitcnt lgkmcnt(4)
    s_setprio 0
    v_mfma_f32_32x32x16_bf16 v[32:47], v[16:19], v[128:131], v[32:47]
    s_setprio 2
    s_setprio 0
    v_mfma_f32_32x32x16_bf16 v[48:63], v[16:19], v[132:135], v[48:63]
    s_setprio 2
    s_setprio 0
    v_mfma_f32_32x32x16_bf16 v[64:79], v[20:23], v[128:131], v[64:79]
    s_setprio 2
    s_setprio 0
    v_mfma_f32_32x32x16_bf16 v[80:95], v[20:23], v[132:135], v[80:95]
    s_setprio 2
    s_waitcnt lgkmcnt(0)
    s_setprio 0
    v_mfma_f32_32x32x16_bf16 v[32:47], v[24:27], v[136:139], v[32:47]
    s_setprio 2
    s_setprio 0
    v_mfma_f32_32x32x16_bf16 v[48:63], v[24:27], v[140:143], v[48:63]
    s_setprio 2
    s_setprio 0
    v_mfma_f32_32x32x16_bf16 v[64:79], v[28:31], v[136:139], v[64:79]
    s_setprio 2
    s_setprio 0
    v_mfma_f32_32x32x16_bf16 v[80:95], v[28:31], v[140:143], v[80:95]
    s_setprio 2
    s_add_u32 m0, s56, 0
    s_lshl_b32 s37, s47, 17
    s_add_u32 s37, s37, 32768
    s_add_u32 s37, s37, s45
    s_waitcnt vmcnt(2)
    buffer_load_dwordx4 v8, s[32:35], s37 offen offset:0 lds
    buffer_load_dwordx4 v9, s[32:35], s37 offen offset:1024 lds
    buffer_load_dwordx4 v10, s[32:35], s37 offen offset:2048 lds
    buffer_load_dwordx4 v11, s[32:35], s37 offen offset:3072 lds
    s_waitcnt vmcnt(24)
    ds_read_b64_tr_b16 v[16:17], v12 offset:4096
    ds_read_b64_tr_b16 v[18:19], v12 offset:5120
    ds_read_b64_tr_b16 v[20:21], v13 offset:4096
    ds_read_b64_tr_b16 v[22:23], v13 offset:5120
    ds_read_b64_tr_b16 v[24:25], v12 offset:6144
    ds_read_b64_tr_b16 v[26:27], v12 offset:7168
    ds_read_b64_tr_b16 v[28:29], v13 offset:6144
    ds_read_b64_tr_b16 v[30:31], v13 offset:7168
    s_waitcnt lgkmcnt(4)
    s_setprio 0
    v_mfma_f32_32x32x16_bf16 v[32:47], v[16:19], v[144:147], v[32:47]
    s_setprio 2
    s_setprio 0
    v_mfma_f32_32x32x16_bf16 v[48:63], v[16:19], v[148:151], v[48:63]
    s_setprio 2
    s_setprio 0
    v_mfma_f32_32x32x16_bf16 v[64:79], v[20:23], v[144:147], v[64:79]
    s_setprio 2
    s_setprio 0
    v_mfma_f32_32x32x16_bf16 v[80:95], v[20:23], v[148:151], v[80:95]
    s_setprio 2
    s_waitcnt lgkmcnt(0)
    s_setprio 0
    v_mfma_f32_32x32x16_bf16 v[32:47], v[24:27], v[152:155], v[32:47]
    s_setprio 2
    s_setprio 0
    v_mfma_f32_32x32x16_bf16 v[48:63], v[24:27], v[156:159], v[48:63]
    s_setprio 2
    s_setprio 0
    v_mfma_f32_32x32x16_bf16 v[64:79], v[28:31], v[152:155], v[64:79]
    s_setprio 2
    s_setprio 0
    v_mfma_f32_32x32x16_bf16 v[80:95], v[28:31], v[156:159], v[80:95]
    s_setprio 2
    s_add_u32 m0, s56, 4096
    s_lshl_b32 s37, s47, 17
    s_add_u32 s37, s37, 65536
    s_add_u32 s37, s37, s45
    s_waitcnt vmcnt(2)
    buffer_load_dwordx4 v8, s[32:35], s37 offen offset:0 lds
    buffer_load_dwordx4 v9, s[32:35], s37 offen offset:1024 lds
    buffer_load_dwordx4 v10, s[32:35], s37 offen offset:2048 lds
    buffer_load_dwordx4 v11, s[32:35], s37 offen offset:3072 lds
    s_waitcnt vmcnt(20)
    ds_read_b64_tr_b16 v[16:17], v12 offset:8192
    ds_read_b64_tr_b16 v[18:19], v12 offset:9216
    ds_read_b64_tr_b16 v[20:21], v13 offset:8192
    ds_read_b64_tr_b16 v[22:23], v13 offset:9216
    ds_read_b64_tr_b16 v[24:25], v12 offset:10240
    ds_read_b64_tr_b16 v[26:27], v12 offset:11264
    ds_read_b64_tr_b16 v[28:29], v13 offset:10240
    ds_read_b64_tr_b16 v[30:31], v13 offset:11264
    s_waitcnt lgkmcnt(4)
    s_setprio 0
    v_mfma_f32_32x32x16_bf16 v[32:47], v[16:19], v[96:99], v[32:47]
    s_setprio 2
    s_setprio 0
    v_mfma_f32_32x32x16_bf16 v[48:63], v[16:19], v[100:103], v[48:63]
    s_setprio 2
    s_setprio 0
    v_mfma_f32_32x32x16_bf16 v[64:79], v[20:23], v[96:99], v[64:79]
    s_setprio 2
    s_setprio 0
    v_mfma_f32_32x32x16_bf16 v[80:95], v[20:23], v[100:103], v[80:95]
    s_setprio 2
    s_waitcnt lgkmcnt(0)
    s_setprio 0
    v_mfma_f32_32x32x16_bf16 v[32:47], v[24:27], v[104:107], v[32:47]
    s_setprio 2
    s_setprio 0
    v_mfma_f32_32x32x16_bf16 v[48:63], v[24:27], v[108:111], v[48:63]
    s_setprio 2
    s_setprio 0
    v_mfma_f32_32x32x16_bf16 v[64:79], v[28:31], v[104:107], v[64:79]
    s_setprio 2
    s_setprio 0
    v_mfma_f32_32x32x16_bf16 v[80:95], v[28:31], v[108:111], v[80:95]
    s_setprio 2
    s_add_u32 m0, s56, 8192
    s_lshl_b32 s37, s47, 17
    s_add_u32 s37, s37, 98304
    s_add_u32 s37, s37, s45
    s_waitcnt vmcnt(2)
    buffer_load_dwordx4 v8, s[32:35], s37 offen offset:0 lds
    buffer_load_dwordx4 v9, s[32:35], s37 offen offset:1024 lds
    buffer_load_dwordx4 v10, s[32:35], s37 offen offset:2048 lds
    buffer_load_dwordx4 v11, s[32:35], s37 offen offset:3072 lds
    s_waitcnt vmcnt(16)
    ds_read_b64_tr_b16 v[16:17], v12 offset:12288
    ds_read_b64_tr_b16 v[18:19], v12 offset:13312
    ds_read_b64_tr_b16 v[20:21], v13 offset:12288
    ds_read_b64_tr_b16 v[22:23], v13 offset:13312
    ds_read_b64_tr_b16 v[24:25], v12 offset:14336
    ds_read_b64_tr_b16 v[26:27], v12 offset:15360
    ds_read_b64_tr_b16 v[28:29], v13 offset:14336
    ds_read_b64_tr_b16 v[30:31], v13 offset:15360
    s_waitcnt lgkmcnt(4)
    s_setprio 0
    v_mfma_f32_32x32x16_bf16 v[32:47], v[16:19], v[112:115], v[32:47]
    s_setprio 2
    s_setprio 0
    v_mfma_f32_32x32x16_bf16 v[48:63], v[16:19], v[116:119], v[48:63]
    s_setprio 2
    s_setprio 0
    v_mfma_f32_32x32x16_bf16 v[64:79], v[20:23], v[112:115], v[64:79]
    s_setprio 2
    s_setprio 0
    v_mfma_f32_32x32x16_bf16 v[80:95], v[20:23], v[116:119], v[80:95]
    s_setprio 2
    s_waitcnt lgkmcnt(0)
    s_setprio 0
    v_mfma_f32_32x32x16_bf16 v[32:47], v[24:27], v[120:123], v[32:47]
    s_setprio 2
    s_setprio 0
    v_mfma_f32_32x32x16_bf16 v[48:63], v[24:27], v[124:127], v[48:63]
    s_setprio 2
    s_setprio 0
    v_mfma_f32_32x32x16_bf16 v[64:79], v[28:31], v[120:123], v[64:79]
    s_setprio 2
    s_setprio 0
    v_mfma_f32_32x32x16_bf16 v[80:95], v[28:31], v[124:127], v[80:95]
    s_setprio 2
    s_mov_b32 s40, s50
    s_setprio 0
    s_mov_b32 s62, 0x20000
    s_mov_b32 exec_lo, 0xff
    s_mov_b32 exec_hi, 0
L_f_pollo:
    buffer_load_dwordx2 v[16:17], v165, s[24:27], s40 offen sc1
    s_waitcnt vmcnt(0)
    v_cmp_ne_u64 vcc, s[60:61], v[16:17]
    s_sub_u32 s62, s62, 1
    s_cbranch_scc1 L_f_pollo_ok
    s_cbranch_vccz L_f_pollo_ok
    s_sleep 2
    s_branch L_f_pollo
L_f_pollo_ok:
    s_mov_b64 exec, -1
    s_setprio 3
    s_lshl_b32 s37, s47, 13
    s_add_u32 s37, s37, 0
    s_add_u32 s38, s37, s53
    s_add_u32 s37, s37, s46
    buffer_load_dwordx4 v[128:131], v3, s[24:27], s37 offen offset:0 sc1
    buffer_load_dwordx4 v[132:135], v3, s[24:27], s38 offen offset:0 sc1
    buffer_load_dwordx4 v[136:139], v3, s[24:27], s37 offen offset:1024 sc1
    buffer_load_dwordx4 v[140:143], v3, s[24:27], s38 offen offset:1024 sc1
    s_lshl_b32 s37, s47, 13
    s_add_u32 s37, s37, 2048
    s_add_u32 s38, s37, s53
    s_add_u32 s37, s37, s46
    buffer_load_dwordx4 v[144:147], v3, s[24:27], s37 offen offset:0 sc1
    buffer_load_dwordx4 v[148:151], v3, s[24:27], s38 offen offset:0 sc1
    buffer_load_dwordx4 v[152:155], v3, s[24:27], s37 offen offset:1024 sc1
    buffer_load_dwordx4 v[156:159], v3, s[24:27], s38 offen offset:1024 sc1
    s_lshl_b32 s37, s47, 13
    s_add_u32 s37, s37, 4096
    s_add_u32 s38, s37, s53
    s_add_u32 s37, s37, s46
    buffer_load_dwordx4 v[96:99], v3, s[24:27], s37 offen offset:0 sc1
    buffer_load_dwordx4 v[100:103], v3, s[24:27], s38 offen offset:0 sc1
    buffer_load_dwordx4 v[104:107], v3, s[24:27], s37 offen offset:1024 sc1
    buffer_load_dwordx4 v[108:111], v3, s[24:27], s38 offen offset:1024 sc1
    s_lshl_b32 s37, s47, 13
    s_add_u32 s37, s37, 6144
    s_add_u32 s38, s37, s53
    s_add_u32 s37, s37, s46
    buffer_load_dwordx4 v[112:115], v3, s[24:27], s37 offen offset:0 sc1
    buffer_load_dwordx4 v[116:119], v3, s[24:27], s38 offen offset:0 sc1
    buffer_load_dwordx4 v[120:123], v3, s[24:27], s37 offen offset:1024 sc1
    buffer_load_dwordx4 v[124:127], v3, s[24:27], s38 offen offset:1024 sc1
    ds_read_b64_tr_b16 v[16:17], v12 offset:16384
    ds_read_b64_tr_b16 v[18:19], v12 offset:17408
    ds_read_b64_tr_b16 v[20:21], v13 offset:16384
    ds_read_b64_tr_b16 v[22:23], v13 offset:17408
    ds_read_b64_tr_b16 v[24:25], v12 offset:18432
    ds_read_b64_tr_b16 v[26:27], v12 offset:19456
    ds_read_b64_tr_b16 v[28:29], v13 offset:18432
    ds_read_b64_tr_b16 v[30:31], v13 offset:19456
    s_waitcnt vmcnt(12)
    s_waitcnt lgkmcnt(4)
    v_mfma_f32_32x32x16_bf16 v[32:47], v[16:19], v[128:131], v[32:47]
    v_mfma_f32_32x32x16_bf16 v[48:63], v[16:19], v[132:135], v[48:63]
    v_mfma_f32_32x32x16_bf16 v[64:79], v[20:23], v[128:131], v[64:79]
    v_mfma_f32_32x32x16_bf16 v[80:95], v[20:23], v[132:135], v[80:95]
    s_waitcnt lgkmcnt(0)
    v_mfma_f32_32x32x16_bf16 v[32:47], v[24:27], v[136:139], v[32:47]
    v_mfma_f32_32x32x16_bf16 v[48:63], v[24:27], v[140:143], v[48:63]
    v_mfma_f32_32x32x16_bf16 v[64:79], v[28:31], v[136:139], v[64:79]
    v_mfma_f32_32x32x16_bf16 v[80:95], v[28:31], v[140:143], v[80:95]
    ds_read_b64_tr_b16 v[16:17], v12 offset:0
    ds_read_b64_tr_b16 v[18:19], v12 offset:1024
    ds_read_b64_tr_b16 v[20:21], v13 offset:0
    ds_read_b64_tr_b16 v[22:23], v13 offset:1024
    ds_read_b64_tr_b16 v[24:25], v12 offset:2048
    ds_read_b64_tr_b16 v[26:27], v12 offset:3072
    ds_read_b64_tr_b16 v[28:29], v13 offset:2048
    ds_read_b64_tr_b16 v[30:31], v13 offset:3072
    s_waitcnt vmcnt(8)
    s_waitcnt lgkmcnt(4)
    v_mfma_f32_32x32x16_bf16 v[32:47], v[16:19], v[144:147], v[32:47]
    v_mfma_f32_32x32x16_bf16 v[48:63], v[16:19], v[148:151], v[48:63]
    v_mfma_f32_32x32x16_bf16 v[64:79], v[20:23], v[144:147], v[64:79]
    v_mfma_f32_32x32x16_bf16 v[80:95], v[20:23], v[148:151], v[80:95]
    s_waitcnt lgkmcnt(0)
    v_mfma_f32_32x32x16_bf16 v[32:47], v[24:27], v[152:155], v[32:47]
    v_mfma_f32_32x32x16_bf16 v[48:63], v[24:27], v[156:159], v[48:63]
    v_mfma_f32_32x32x16_bf16 v[64:79], v[28:31], v[152:155], v[64:79]
    v_mfma_f32_32x32x16_bf16 v[80:95], v[28:31], v[156:159], v[80:95]
    ds_read_b64_tr_b16 v[16:17], v12 offset:4096
    ds_read_b64_tr_b16 v[18:19], v12 offset:5120
    ds_read_b64_tr_b16 v[20:21], v13 offset:4096
    ds_read_b64_tr_b16 v[22:23], v13 offset:5120
    ds_read_b64_tr_b16 v[24:25], v12 offset:6144
    ds_read_b64_tr_b16 v[26:27], v12 offset:7168
    ds_read_b64_tr_b16 v[28:29], v13 offset:6144
    ds_read_b64_tr_b16 v[30:31], v13 offset:7168
    s_waitcnt vmcnt(4)
    s_waitcnt lgkmcnt(4)
    v_mfma_f32_32x32x16_bf16 v[32:47], v[16:19], v[96:99], v[32:47]
    v_mfma_f32_32x32x16_bf16 v[48:63], v[16:19], v[100:103], v[48:63]
    v_mfma_f32_32x32x16_bf16 v[64:79], v[20:23], v[96:99], v[64:79]
    v_mfma_f32_32x32x16_bf16 v[80:95], v[20:23], v[100:103], v[80:95]
    s_waitcnt lgkmcnt(0)
    v_mfma_f32_32x32x16_bf16 v[32:47], v[24:27], v[104:107], v[32:47]
    v_mfma_f32_32x32x16_bf16 v[48:63], v[24:27], v[108:111], v[48:63]
    v_mfma_f32_32x32x16_bf16 v[64:79], v[28:31], v[104:107], v[64:79]
    v_mfma_f32_32x32x16_bf16 v[80:95], v[28:31], v[108:111], v[80:95]
    ds_read_b64_tr_b16 v[16:17], v12 offset:8192
    ds_read_b64_tr_b16 v[18:19], v12 offset:9216
    ds_read_b64_tr_b16 v[20:21], v13 offset:8192
    ds_read_b64_tr_b16 v[22:23], v13 offset:9216
    ds_read_b64_tr_b16 v[24:25], v12 offset:10240
    ds_read_b64_tr_b16 v[26:27], v12 offset:11264
    ds_read_b64_tr_b16 v[28:29], v13 offset:10240
    ds_read_b64_tr_b16 v[30:31], v13 offset:11264
    s_waitcnt vmcnt(0)
    s_waitcnt lgkmcnt(4)
    v_mfma_f32_32x32x16_bf16 v[32:47], v[16:19], v[112:115], v[32:47]
    v_mfma_f32_32x32x16_bf16 v[48:63], v[16:19], v[116:119], v[48:63]
    v_mfma_f32_32x32x16_bf16 v[64:79], v[20:23], v[112:115], v[64:79]
    v_mfma_f32_32x32x16_bf16 v[80:95], v[20:23], v[116:119], v[80:95]
    s_waitcnt lgkmcnt(0)
    v_mfma_f32_32x32x16_bf16 v[32:47], v[24:27], v[120:123], v[32:47]
    v_mfma_f32_32x32x16_bf16 v[48:63], v[24:27], v[124:127], v[48:63]
    v_mfma_f32_32x32x16_bf16 v[64:79], v[28:31], v[120:123], v[64:79]
    v_mfma_f32_32x32x16_bf16 v[80:95], v[28:31], v[124:127], v[80:95]
    s_nop 9
    ds_write_b128 v5, v[48:51] offset:0
    ds_write_b128 v5, v[52:55] offset:1024
    ds_write_b128 v5, v[56:59] offset:2048
    ds_write_b128 v5, v[60:63] offset:3072
    ds_write_b128 v5, v[64:67] offset:4096
    ds_write_b128 v5, v[68:71] offset:5120
    ds_write_b128 v5, v[72:75] offset:6144
    ds_write_b128 v5, v[76:79] offset:7168
    ds_write_b128 v5, v[80:83] offset:8192
    ds_write_b128 v5, v[84:87] offset:9216
    ds_write_b128 v5, v[88:91] offset:10240
    ds_write_b128 v5, v[92:95] offset:11264
    s_waitcnt lgkmcnt(0)
    s_mov_b64 exec, 1
    ds_add_u32 v164, v1 offset:40
    s_mov_b64 exec, -1
    s_mov_b32 s62, 0x200000
L_f_spin3:
    ds_read_b32 v0, v164 offset:40
    s_waitcnt lgkmcnt(0)
    v_readfirstlane_b32 s37, v0
    s_nop 0
    s_cmp_ge_u32 s37, 40
    s_cbranch_scc1 L_f_spin3_ok
    s_sleep 1
    s_sub_u32 s62, s62, 1
    s_cbranch_scc0 L_f_spin3
L_f_spin3_ok:
    ds_read_b128 v[48:51], v160 offset:0
    ds_read_b128 v[52:55], v160 offset:1024
    ds_read_b128 v[56:59], v160 offset:2048
    ds_read_b128 v[60:63], v160 offset:3072
    ds_read_b128 v[64:67], v161 offset:0
    ds_read_b128 v[68:71], v161 offset:1024
    ds_read_b128 v[72:75], v161 offset:2048
    ds_read_b128 v[76:79], v161 offset:3072
    ds_read_b128 v[80:83], v162 offset:0
    ds_read_b128 v[84:87], v162 offset:1024
    ds_read_b128 v[88:91], v162 offset:2048
    ds_read_b128 v[92:95], v162 offset:3072
    s_waitcnt lgkmcnt(8)
    v_pk_add_f32 v[32:33], v[32:33], v[48:49]
    v_pk_add_f32 v[34:35], v[34:35], v[50:51]
    v_pk_add_f32 v[36:37], v[36:37], v[52:53]
    v_pk_add_f32 v[38:39], v[38:39], v[54:55]
    v_pk_add_f32 v[40:41], v[40:41], v[56:57]
    v_pk_add_f32 v[42:43], v[42:43], v[58:59]
    v_pk_add_f32 v[44:45], v[44:45], v[60:61]
    v_pk_add_f32 v[46:47], v[46:47], v[62:63]
    s_waitcnt lgkmcnt(4)
    v_pk_add_f32 v[32:33], v[32:33], v[64:65]
    v_pk_add_f32 v[34:35], v[34:35], v[66:67]
    v_pk_add_f32 v[36:37], v[36:37], v[68:69]
    v_pk_add_f32 v[38:39], v[38:39], v[70:71]
    v_pk_add_f32 v[40:41], v[40:41], v[72:73]
    v_pk_add_f32 v[42:43], v[42:43], v[74:75]
    v_pk_add_f32 v[44:45], v[44:45], v[76:77]
    v_pk_add_f32 v[46:47], v[46:47], v[78:79]
    s_waitcnt lgkmcnt(0)
    v_pk_add_f32 v[32:33], v[32:33], v[80:81]
    v_pk_add_f32 v[34:35], v[34:35], v[82:83]
    v_pk_add_f32 v[36:37], v[36:37], v[84:85]
    v_pk_add_f32 v[38:39], v[38:39], v[86:87]
    v_pk_add_f32 v[40:41], v[40:41], v[88:89]
    v_pk_add_f32 v[42:43], v[42:43], v[90:91]
    v_pk_add_f32 v[44:45], v[44:45], v[92:93]
    v_pk_add_f32 v[46:47], v[46:47], v[94:95]
    v_cvt_pk_bf16_f32 v96, v32, v33
    v_cvt_pk_bf16_f32 v97, v34, v35
    v_cvt_pk_bf16_f32 v98, v36, v37
    v_cvt_pk_bf16_f32 v99, v38, v39
    v_cvt_pk_bf16_f32 v100, v40, v41
    v_cvt_pk_bf16_f32 v101, v42, v43
    v_cvt_pk_bf16_f32 v102, v44, v45
    v_cvt_pk_bf16_f32 v103, v46, v47
    buffer_store_dwordx4 v[96:99], v4, s[16:19], s48 offen
    buffer_store_dwordx4 v[100:103], v4, s[16:19], s48 offen offset:32
L_f_ep:
    s_add_u32 s37, s2, s47
    s_cmp_lg_u32 s37, 0
    s_cbranch_scc1 L_f_noep
    s_mov_b32 s37, 33554432
    s_mov_b64 exec, 1
    buffer_store_dword v166, v3, s[24:27], s37 offen
    s_mov_b64 exec, -1
L_f_noep:
    s_endpgm
L_f_d_slow:
    s_mov_b32 s62, 0x200000
L_f_dspin:
    ds_read_b32 v0, v164 offset:40
    s_waitcnt lgkmcnt(0)
    v_readfirstlane_b32 s37, v0
    s_nop 0
    s_cmp_ge_u32 s37, s20
    s_cbranch_scc1 L_f_dspin_ok
    s_sleep 1
    s_sub_u32 s62, s62, 1
    s_cbranch_scc0 L_f_dspin
L_f_dspin_ok:
    s_branch L_f_d_back
L_f_r_slow:
    s_mov_b32 s62, 0x200000
L_f_rspin:
    ds_read_b32 v0, v164 offset:4
    s_waitcnt lgkmcnt(0)
    v_readfirstlane_b32 s37, v0
    s_nop 0
    s_cmp_ge_u32 s37, s11
    s_cbranch_scc1 L_f_rspin_ok
    s_sleep 1
    s_sub_u32 s62, s62, 1
    s_cbranch_scc0 L_f_rspin
L_f_rspin_ok:
    s_branch L_f_r_back
L_role_a:
    s_setprio 3
    s_mov_b32 s10, s37
    s_mov_b32 s11, s38
    v_lshrrev_b32 v4, 4, v2
    v_and_b32 v5, 15, v2
    v_xor_b32 v5, v5, v4
    v_lshlrev_b32 v4, 10, v4
    v_lshl_add_u32 v116, v5, 4, v4
    s_and_b32 s38, s36, 3
    s_lshl_b32 s38, s38, 6
    s_and_b32 s37, s37, 0xffff
    v_xor_b32 v116, s38, v116
    v_add_u32 v116, s37, v116
    v_xor_b32 v117, 0x8000, v116
    s_and_b32 s38, s36, 1
    s_lshl_b32 s38, s38, 7
    v_and_b32 v4, 31, v2
    v_lshrrev_b32 v5, 5, v2
    v_and_b32 v6, 15, v2
    v_xor_b32 v6, v6, v5
    v_lshlrev_b32 v6, 4, v6
    v_lshl_add_u32 v12, v4, 10, v6
    s_lshr_b32 s37, s36, 1
    s_lshl2_add_u32 s39, s44, s37
    s_lshl_b32 s38, s38, 8
    s_lshl_b32 s40, s39, 5
    s_add_u32 s40, s40, s38
    v_xor_b32 v113, s40, v12
    s_lshl_b32 s14, s43, 16
    s_add_u32 s14, s14, s38
    s_lshl_b32 s39, s39, 10
    s_add_u32 s14, s14, s39
    s_min_u32 s38, s37, 2
    s_sub_u32 s39, s37, s38
    s_lshl_b32 s40, s39, 15
    v_add_u32 v12, s40, v12
    v_bfe_u32 v6, v2, 2, 2
    v_and_b32 v7, 3, v2
    v_lshlrev_b32 v7, 3, v7
    v_lshl_add_u32 v14, v5, 3, v6
    v_mul_u32_u24 v14, 192, v14
    v_bfe_u32 v15, v2, 4, 1
    v_mul_u32_u24 v15, 12320, v15
    v_add3_u32 v10, v14, v15, v7
    v_and_b32 v13, 16, v2
    v_lshl_add_u32 v7, v13, 1, v7
    s_and_b32 s37, s36, 1
    s_lshl_b32 s40, s37, 6
    v_add_u32 v7, s40, v7
    v_lshlrev_b32 v14, 5, v6
    v_and_b32 v14, 64, v14
    v_xor_b32 v7, v7, v14
    v_lshl_add_u32 v7, v6, 7, v7
    v_mul_u32_u24 v14, 3072, v5
    s_lshl_b32 s40, s38, 10
    v_add3_u32 v17, v7, v14, s40
    v_and_b32 v6, 15, v2
    v_lshlrev_b32 v6, 4, v6
    v_lshl_add_u32 v47, v5, 8, v6
    s_lshl1_add_u32 s40, s38, s37
    s_lshl_b32 s57, s40, 5
    v_add_u32 v10, s57, v10
    s_lshl1_add_u32 s37, s44, s37
    s_lshl1_add_u32 s39, s43, s39
    s_mul_i32 s57, s44, 6
    s_add_u32 s57, s57, s40
    s_lshl_b32 s57, s57, 10
    s_mul_i32 s12, s39, 147456
    s_add_u32 s12, s12, s57
    s_add_u32 s12, s12, 8486912
    s_add_u32 s13, s12, 147456
    s_lshl_b32 s45, s37, 17
    s_lshl_b32 s40, s39, 10
    s_add_u32 s45, s45, s40
    s_add_u32 s45, s45, 2097152
    s_min_u32 s40, s38, 1
    s_lshl_b32 s45, s45, s40
    s_lshl_b32 s46, 65536, s40
    s_add_u32 s46, s46, s45
    s_lshl_b32 s57, 1024, s40
    v_add_u32 v19, s57, v3
    v_lshl_add_u32 v115, v13, 13, v47
    s_cmp_eq_u32 s38, 0
    s_cselect_b32 s48, 0x3eb8aa3b, 1.0
    v_mov_b32 v44, 156032
    v_mov_b64 v[48:49], 0
    v_mov_b64 v[50:51], 0
    v_mov_b64 v[52:53], 0
    v_mov_b64 v[54:55], 0
    v_mov_b64 v[56:57], 0
    v_mov_b64 v[58:59], 0
    v_mov_b64 v[60:61], 0
    v_mov_b64 v[62:63], 0
    v_mov_b64 v[64:65], 0
    v_mov_b64 v[66:67], 0
    v_mov_b64 v[68:69], 0
    v_mov_b64 v[70:71], 0
    v_mov_b64 v[72:73], 0
    v_mov_b64 v[74:75], 0
    v_mov_b64 v[76:77], 0
    v_mov_b64 v[78:79], 0
    v_mov_b64 v[80:81], 0
    v_mov_b64 v[82:83], 0
    v_mov_b64 v[84:85], 0
    v_mov_b64 v[86:87], 0
    v_mov_b64 v[88:89], 0
    v_mov_b64 v[90:91], 0
    v_mov_b64 v[92:93], 0
    v_mov_b64 v[94:95], 0
    v_mov_b64 v[96:97], 0
    v_mov_b64 v[98:99], 0
    v_mov_b64 v[100:101], 0
    v_mov_b64 v[102:103], 0
    v_mov_b64 v[104:105], 0
    v_mov_b64 v[106:107], 0
    v_mov_b64 v[108:109], 0
    v_mov_b64 v[110:111], 0
    v_mov_b32 v4, s48
    ds_write_b128 v44, v[48:51]
    ds_write_b128 v44, v[48:51] offset:16
    ds_write_b128 v44, v[48:51] offset:32
    s_mov_b32 s28, 90240
    s_mov_b32 s29, 8
    s_and_b32 s31, s42, 7
    s_lshl_b32 s31, s31, 7
    v_xor_b32 v13, s31, v12
    v_add_u32 v18, s28, v17
    v_xor_b32 v14, 32, v13
    v_xor_b32 v15, 64, v13
    v_xor_b32 v16, 96, v13
    s_add_u32 s31, s31, 128
    s_and_b32 s31, s31, 0x3ff
    s_add_u32 s28, s28, 24704
    s_cmp_eq_u32 s28, 139648
    s_cselect_b32 s28, 65536, s28
    buffer_load_dwordx4 v[148:151], v164, s[32:35], s11 offen offset:0
    buffer_load_dwordx4 v[152:155], v164, s[32:35], s11 offen offset:256
    buffer_load_dwordx4 v[156:159], v164, s[32:35], s11 offen offset:512
    buffer_load_dwordx4 v[160:163], v164, s[32:35], s11 offen offset:768
    s_lshr_b32 s39, s42, 3
    s_lshl2_add_u32 s49, s41, s39
    s_and_b32 s52, s42, 7
    s_and_b32 s37, s36, 3
    s_lshl_b32 s37, s37, 1
    s_lshl3_add_u32 s50, s52, s37
    s_lshr_b32 s57, s36, 2
    s_add_u32 s50, s50, s57
    s_lshl_b32 s53, s36, 11
    s_lshl_b32 s54, s49, 17
    s_add_u32 s54, s54, 4194304
    s_add_u32 s51, s54, s53
    s_lshl_b32 s55, s49, 16
    s_lshl_b32 s39, s50, 10
    s_add_u32 s55, s55, s39
    s_add_u32 s55, s55, 2097152
    v_mov_b32 v6, 0
    s_mov_b32 exec_lo, 0x00110000
    s_mov_b32 exec_hi, 0x00110000
    v_mov_b32 v6, s3
    s_mov_b64 exec, -1
    v_mov_b32 v11, v6
    s_mov_b32 s52, 16384
    s_add_u32 s53, s53, 16384
    s_mov_b32 s58, 0x0000ffff
    s_mov_b32 s59, 0x0000ffff
    s_lshl_b32 s57, s57, 13
    s_add_u32 s57, s57, 65536
    v_add_u32 v8, s57, v3
    v_add_u32 v9, s57, v47
    v_mov_b32 v45, 1
    v_mov_b64 v[40:41], 0
    v_mov_b64 v[42:43], 0
    v_mov_b32 v36, 0xc0135761
    v_mov_b32 v38, 0xbdd2d3e8
    s_waitcnt lgkmcnt(0)
    s_add_u32 s60, s60, 1
    s_xor_b32 s61, s60, 0x5bd1e995
    v_mov_b32 v166, s60
    v_mov_b32 v167, s61
    s_waitcnt vmcnt(4)
    v_dot2_f32_bf16 v120, v132, s3, 0
    v_dot2_f32_bf16 v121, v132, v132, 0
    v_dot2_f32_bf16 v122, v133, s3, 0
    v_dot2_f32_bf16 v123, v133, v133, 0
    v_dot2_f32_bf16 v124, v134, s3, 0
    v_dot2_f32_bf16 v125, v134, v134, 0
    v_dot2_f32_bf16 v126, v135, s3, 0
    v_dot2_f32_bf16 v127, v135, v135, 0
    v_dot2_f32_bf16 v120, v136, s3, v120
    v_dot2_f32_bf16 v121, v136, v136, v121
    v_dot2_f32_bf16 v122, v137, s3, v122
    v_dot2_f32_bf16 v123, v137, v137, v123
    v_dot2_f32_bf16 v124, v138, s3, v124
    v_dot2_f32_bf16 v125, v138, v138, v125
    v_dot2_f32_bf16 v126, v139, s3, v126
    v_dot2_f32_bf16 v127, v139, v139, v127
    v_dot2_f32_bf16 v120, v140, s3, v120
    v_dot2_f32_bf16 v121, v140, v140, v121
    v_dot2_f32_bf16 v122, v141, s3, v122
    v_dot2_f32_bf16 v123, v141, v141, v123
    v_dot2_f32_bf16 v124, v142, s3, v124
    v_dot2_f32_bf16 v125, v142, v142, v125
    v_dot2_f32_bf16 v126, v143, s3, v126
    v_dot2_f32_bf16 v127, v143, v143, v127
    v_dot2_f32_bf16 v120, v144, s3, v120
    v_dot2_f32_bf16 v121, v144, v144, v121
    v_dot2_f32_bf16 v122, v145, s3, v122
    v_dot2_f32_bf16 v123, v145, v145, v123
    v_dot2_f32_bf16 v124, v146, s3, v124
    v_dot2_f32_bf16 v125, v146, v146, v125
    v_dot2_f32_bf16 v126, v147, s3, v126
    v_dot2_f32_bf16 v127, v147, v147, v127
    v_pk_add_f32 v[120:121], v[120:121], v[122:123]
    v_lshlrev_b32 v20, 16, v132
    v_and_b32 v21, 0xffff0000, v132
    v_pk_add_f32 v[124:125], v[124:125], v[126:127]
    v_lshlrev_b32 v22, 16, v133
    v_pk_add_f32 v[118:119], v[120:121], v[124:125]
    v_and_b32 v23, 0xffff0000, v133
    v_lshlrev_b32 v24, 16, v134
    v_add_f32_dpp v118, v118, v118 row_ror:8 row_mask:0xf bank_mask:0xf
    v_add_f32_dpp v119, v119, v119 row_ror:8 row_mask:0xf bank_mask:0xf
    v_and_b32 v25, 0xffff0000, v134
    v_add_f32_dpp v118, v118, v118 row_ror:4 row_mask:0xf bank_mask:0xf
    v_add_f32_dpp v119, v119, v119 row_ror:4 row_mask:0xf bank_mask:0xf
    v_lshlrev_b32 v26, 16, v135
    v_add_f32_dpp v118, v118, v118 row_ror:2 row_mask:0xf bank_mask:0xf
    v_add_f32_dpp v119, v119, v119 row_ror:2 row_mask:0xf bank_mask:0xf
    v_and_b32 v27, 0xffff0000, v135
    v_add_f32_dpp v118, v118, v118 row_ror:1 row_mask:0xf bank_mask:0xf
    v_add_f32_dpp v119, v119, v119 row_ror:1 row_mask:0xf bank_mask:0xf
    v_lshlrev_b32 v28, 16, v136
    v_mul_f32 v118, 0x3b000000, v118
    v_mul_f32 v119, 0x3b000000, v119
    v_fma_f32 v119, -v118, v118, v119
    v_max_f32 v119, 0, v119
    v_cvt_pk_bf16_f32 v119, v119, v119
    v_and_b32 v29, 0xffff0000, v136
    v_and_b32 v119, 0xffff0000, v119
    v_cvt_pk_bf16_f32 v118, v118, v118
    v_lshlrev_b32 v30, 16, v137
    v_and_b32 v118, 0xffff0000, v118
    v_add_f32 v119, 0x3727c5ac, v119
    v_cvt_pk_bf16_f32 v119, v119, v119
    v_and_b32 v31, 0xffff0000, v137
    v_and_b32 v119, 0xffff0000, v119
    v_sqrt_f32 v119, v119
    v_lshlrev_b32 v32, 16, v138
    v_cvt_pk_bf16_f32 v119, v119, v119
    v_and_b32 v33, 0xffff0000, v138
    v_and_b32 v119, 0xffff0000, v119
    v_rcp_f32 v119, v119
    v_lshlrev_b32 v34, 16, v139
    v_mul_f32_e64 v118, -v118, v119
    v_and_b32 v35, 0xffff0000, v139
    v_pk_fma_f32 v[20:21], v[20:21], v[118:119], v[118:119] op_sel:[0,1,0] op_sel_hi:[1,1,0]
    v_pk_fma_f32 v[22:23], v[22:23], v[118:119], v[118:119] op_sel:[0,1,0] op_sel_hi:[1,1,0]
    v_pk_fma_f32 v[24:25], v[24:25], v[118:119], v[118:119] op_sel:[0,1,0] op_sel_hi:[1,1,0]
    v_pk_fma_f32 v[26:27], v[26:27], v[118:119], v[118:119] op_sel:[0,1,0] op_sel_hi:[1,1,0]
    v_cvt_pk_bf16_f32 v132, v20, v21
    v_cvt_pk_bf16_f32 v133, v22, v23
    v_cvt_pk_bf16_f32 v134, v24, v25
    v_cvt_pk_bf16_f32 v135, v26, v27
    ds_write_b128 v116, v[132:135] offset:0
    v_lshlrev_b32 v20, 16, v140
    v_and_b32 v21, 0xffff0000, v140
    v_lshlrev_b32 v22, 16, v141
    v_and_b32 v23, 0xffff0000, v141
    v_lshlrev_b32 v24, 16, v142
    v_and_b32 v25, 0xffff0000, v142
    v_lshlrev_b32 v26, 16, v143
    v_and_b32 v27, 0xffff0000, v143
    v_pk_fma_f32 v[28:29], v[28:29], v[118:119], v[118:119] op_sel:[0,1,0] op_sel_hi:[1,1,0]
    v_pk_fma_f32 v[30:31], v[30:31], v[118:119], v[118:119] op_sel:[0,1,0] op_sel_hi:[1,1,0]
    v_pk_fma_f32 v[32:33], v[32:33], v[118:119], v[118:119] op_sel:[0,1,0] op_sel_hi:[1,1,0]
    v_pk_fma_f32 v[34:35], v[34:35], v[118:119], v[118:119] op_sel:[0,1,0] op_sel_hi:[1,1,0]
    v_cvt_pk_bf16_f32 v136, v28, v29
    v_cvt_pk_bf16_f32 v137, v30, v31
    v_cvt_pk_bf16_f32 v138, v32, v33
    v_cvt_pk_bf16_f32 v139, v34, v35
    ds_write_b128 v116, v[136:139] offset:256
    v_lshlrev_b32 v28, 16, v144
    v_and_b32 v29, 0xffff0000, v144
    v_lshlrev_b32 v30, 16, v145
    v_and_b32 v31, 0xffff0000, v145
    v_lshlrev_b32 v32, 16, v146
    v_and_b32 v33, 0xffff0000, v146
    v_lshlrev_b32 v34, 16, v147
    v_and_b32 v35, 0xffff0000, v147
    v_pk_fma_f32 v[20:21], v[20:21], v[118:119], v[118:119] op_sel:[0,1,0] op_sel_hi:[1,1,0]
    v_pk_fma_f32 v[22:23], v[22:23], v[118:119], v[118:119] op_sel:[0,1,0] op_sel_hi:[1,1,0]
    v_pk_fma_f32 v[24:25], v[24:25], v[118:119], v[118:119] op_sel:[0,1,0] op_sel_hi:[1,1,0]
    v_pk_fma_f32 v[26:27], v[26:27], v[118:119], v[118:119] op_sel:[0,1,0] op_sel_hi:[1,1,0]
    v_cvt_pk_bf16_f32 v140, v20, v21
    v_cvt_pk_bf16_f32 v141, v22, v23
    v_cvt_pk_bf16_f32 v142, v24, v25
    v_cvt_pk_bf16_f32 v143, v26, v27
    ds_write_b128 v116, v[140:143] offset:512
    v_pk_fma_f32 v[28:29], v[28:29], v[118:119], v[118:119] op_sel:[0,1,0] op_sel_hi:[1,1,0]
    v_pk_fma_f32 v[30:31], v[30:31], v[118:119], v[118:119] op_sel:[0,1,0] op_sel_hi:[1,1,0]
    v_pk_fma_f32 v[32:33], v[32:33], v[118:119], v[118:119] op_sel:[0,1,0] op_sel_hi:[1,1,0]
    v_pk_fma_f32 v[34:35], v[34:35], v[118:119], v[118:119] op_sel:[0,1,0] op_sel_hi:[1,1,0]
    v_cvt_pk_bf16_f32 v144, v28, v29
    v_cvt_pk_bf16_f32 v145, v30, v31
    v_cvt_pk_bf16_f32 v146, v32, v33
    v_cvt_pk_bf16_f32 v147, v34, v35
    ds_write_b128 v116, v[144:147] offset:768
    s_waitcnt vmcnt(0)
    v_dot2_f32_bf16 v120, v148, s3, 0
    v_dot2_f32_bf16 v121, v148, v148, 0
    v_dot2_f32_bf16 v122, v149, s3, 0
    v_dot2_f32_bf16 v123, v149, v149, 0
    v_dot2_f32_bf16 v124, v150, s3, 0
    v_dot2_f32_bf16 v125, v150, v150, 0
    v_dot2_f32_bf16 v126, v151, s3, 0
    v_dot2_f32_bf16 v127, v151, v151, 0
    v_dot2_f32_bf16 v120, v152, s3, v120
    v_dot2_f32_bf16 v121, v152, v152, v121
    v_dot2_f32_bf16 v122, v153, s3, v122
    v_dot2_f32_bf16 v123, v153, v153, v123
    v_dot2_f32_bf16 v124, v154, s3, v124
    v_dot2_f32_bf16 v125, v154, v154, v125
    v_dot2_f32_bf16 v126, v155, s3, v126
    v_dot2_f32_bf16 v127, v155, v155, v127
    v_dot2_f32_bf16 v120, v156, s3, v120
    v_dot2_f32_bf16 v121, v156, v156, v121
    v_dot2_f32_bf16 v122, v157, s3, v122
    v_dot2_f32_bf16 v123, v157, v157, v123
    v_dot2_f32_bf16 v124, v158, s3, v124
    v_dot2_f32_bf16 v125, v158, v158, v125
    v_dot2_f32_bf16 v126, v159, s3, v126
    v_dot2_f32_bf16 v127, v159, v159, v127
    v_dot2_f32_bf16 v120, v160, s3, v120
    v_dot2_f32_bf16 v121, v160, v160, v121
    v_dot2_f32_bf16 v122, v161, s3, v122
    v_dot2_f32_bf16 v123, v161, v161, v123
    v_dot2_f32_bf16 v124, v162, s3, v124
    v_dot2_f32_bf16 v125, v162, v162, v125
    v_dot2_f32_bf16 v126, v163, s3, v126
    v_dot2_f32_bf16 v127, v163, v163, v127
    v_pk_add_f32 v[120:121], v[120:121], v[122:123]
    v_lshlrev_b32 v20, 16, v148
    v_and_b32 v21, 0xffff0000, v148
    v_pk_add_f32 v[124:125], v[124:125], v[126:127]
    v_lshlrev_b32 v22, 16, v149
    v_pk_add_f32 v[118:119], v[120:121], v[124:125]
    v_and_b32 v23, 0xffff0000, v149
    v_lshlrev_b32 v24, 16, v150
    v_add_f32_dpp v118, v118, v118 row_ror:8 row_mask:0xf bank_mask:0xf
    v_add_f32_dpp v119, v119, v119 row_ror:8 row_mask:0xf bank_mask:0xf
    v_and_b32 v25, 0xffff0000, v150
    v_add_f32_dpp v118, v118, v118 row_ror:4 row_mask:0xf bank_mask:0xf
    v_add_f32_dpp v119, v119, v119 row_ror:4 row_mask:0xf bank_mask:0xf
    v_lshlrev_b32 v26, 16, v151
    v_add_f32_dpp v118, v118, v118 row_ror:2 row_mask:0xf bank_mask:0xf
    v_add_f32_dpp v119, v119, v119 row_ror:2 row_mask:0xf bank_mask:0xf
    v_and_b32 v27, 0xffff0000, v151
    v_add_f32_dpp v118, v118, v118 row_ror:1 row_mask:0xf bank_mask:0xf
    v_add_f32_dpp v119, v119, v119 row_ror:1 row_mask:0xf bank_mask:0xf
    v_lshlrev_b32 v28, 16, v152
    v_mul_f32 v118, 0x3b000000, v118
    v_mul_f32 v119, 0x3b000000, v119
    v_fma_f32 v119, -v118, v118, v119
    v_max_f32 v119, 0, v119
    v_cvt_pk_bf16_f32 v119, v119, v119
    v_and_b32 v29, 0xffff0000, v152
    v_and_b32 v119, 0xffff0000, v119
    v_cvt_pk_bf16_f32 v118, v118, v118
    v_lshlrev_b32 v30, 16, v153
    v_and_b32 v118, 0xffff0000, v118
    v_add_f32 v119, 0x3727c5ac, v119
    v_cvt_pk_bf16_f32 v119, v119, v119
    v_and_b32 v31, 0xffff0000, v153
    v_and_b32 v119, 0xffff0000, v119
    v_sqrt_f32 v119, v119
    v_lshlrev_b32 v32, 16, v154
    v_cvt_pk_bf16_f32 v119, v119, v119
    v_and_b32 v33, 0xffff0000, v154
    v_and_b32 v119, 0xffff0000, v119
    v_rcp_f32 v119, v119
    v_lshlrev_b32 v34, 16, v155
    v_mul_f32_e64 v118, -v118, v119
    v_and_b32 v35, 0xffff0000, v155
    v_pk_fma_f32 v[20:21], v[20:21], v[118:119], v[118:119] op_sel:[0,1,0] op_sel_hi:[1,1,0]
    v_pk_fma_f32 v[22:23], v[22:23], v[118:119], v[118:119] op_sel:[0,1,0] op_sel_hi:[1,1,0]
    v_pk_fma_f32 v[24:25], v[24:25], v[118:119], v[118:119] op_sel:[0,1,0] op_sel_hi:[1,1,0]
    v_pk_fma_f32 v[26:27], v[26:27], v[118:119], v[118:119] op_sel:[0,1,0] op_sel_hi:[1,1,0]
    v_cvt_pk_bf16_f32 v148, v20, v21
    v_cvt_pk_bf16_f32 v149, v22, v23
    v_cvt_pk_bf16_f32 v150, v24, v25
    v_cvt_pk_bf16_f32 v151, v26, v27
    ds_write_b128 v117, v[148:151] offset:0
    v_lshlrev_b32 v20, 16, v156
    v_and_b32 v21, 0xffff0000, v156
    v_lshlrev_b32 v22, 16, v157
    v_and_b32 v23, 0xffff0000, v157
    v_lshlrev_b32 v24, 16, v158
    v_and_b32 v25, 0xffff0000, v158
    v_lshlrev_b32 v26, 16, v159
    v_and_b32 v27, 0xffff0000, v159
    v_pk_fma_f32 v[28:29], v[28:29], v[118:119], v[118:119] op_sel:[0,1,0] op_sel_hi:[1,1,0]
    v_pk_fma_f32 v[30:31], v[30:31], v[118:119], v[118:119] op_sel:[0,1,0] op_sel_hi:[1,1,0]
    v_pk_fma_f32 v[32:33], v[32:33], v[118:119], v[118:119] op_sel:[0,1,0] op_sel_hi:[1,1,0]
    v_pk_fma_f32 v[34:35], v[34:35], v[118:119], v[118:119] op_sel:[0,1,0] op_sel_hi:[1,1,0]
    v_cvt_pk_bf16_f32 v152, v28, v29
    v_cvt_pk_bf16_f32 v153, v30, v31
    v_cvt_pk_bf16_f32 v154, v32, v33
    v_cvt_pk_bf16_f32 v155, v34, v35
    ds_write_b128 v117, v[152:155] offset:256
    v_lshlrev_b32 v28, 16, v160
    v_and_b32 v29, 0xffff0000, v160
    v_lshlrev_b32 v30, 16, v161
    v_and_b32 v31, 0xffff0000, v161
    v_lshlrev_b32 v32, 16, v162
    v_and_b32 v33, 0xffff0000, v162
    v_lshlrev_b32 v34, 16, v163
    v_and_b32 v35, 0xffff0000, v163
    v_pk_fma_f32 v[20:21], v[20:21], v[118:119], v[118:119] op_sel:[0,1,0] op_sel_hi:[1,1,0]
    v_pk_fma_f32 v[22:23], v[22:23], v[118:119], v[118:119] op_sel:[0,1,0] op_sel_hi:[1,1,0]
    v_pk_fma_f32 v[24:25], v[24:25], v[118:119], v[118:119] op_sel:[0,1,0] op_sel_hi:[1,1,0]
    v_pk_fma_f32 v[26:27], v[26:27], v[118:119], v[118:119] op_sel:[0,1,0] op_sel_hi:[1,1,0]
    v_cvt_pk_bf16_f32 v156, v20, v21
    v_cvt_pk_bf16_f32 v157, v22, v23
    v_cvt_pk_bf16_f32 v158, v24, v25
    v_cvt_pk_bf16_f32 v159, v26, v27
    ds_write_b128 v117, v[156:159] offset:512
    v_pk_fma_f32 v[28:29], v[28:29], v[118:119], v[118:119] op_sel:[0,1,0] op_sel_hi:[1,1,0]
    v_pk_fma_f32 v[30:31], v[30:31], v[118:119], v[118:119] op_sel:[0,1,0] op_sel_hi:[1,1,0]
    v_pk_fma_f32 v[32:33], v[32:33], v[118:119], v[118:119] op_sel:[0,1,0] op_sel_hi:[1,1,0]
    v_pk_fma_f32 v[34:35], v[34:35], v[118:119], v[118:119] op_sel:[0,1,0] op_sel_hi:[1,1,0]
    v_cvt_pk_bf16_f32 v160, v28, v29
    v_cvt_pk_bf16_f32 v161, v30, v31
    v_cvt_pk_bf16_f32 v162, v32, v33
    v_cvt_pk_bf16_f32 v163, v34, v35
    ds_write_b128 v117, v[160:163] offset:768
    s_waitcnt lgkmcnt(0)
    s_barrier
    s_setprio 0
    ds_read_b128 v[20:23], v113
    s_cmp_ge_u32 s36, 4
    s_cbranch_scc1 L_p1_v0
    ds_read_b64_tr_b16 v[116:117], v18 offset:0
    ds_read_b64_tr_b16 v[118:119], v18 offset:512
    ds_read_b128 v[120:123], v13 offset:0
    ds_read_b128 v[124:127], v13 offset:32768
    ds_read_b64_tr_b16 v[128:129], v18 offset:6144
    ds_read_b64_tr_b16 v[130:131], v18 offset:6656
    ds_read_b128 v[132:135], v14 offset:0
    ds_read_b128 v[136:139], v14 offset:32768
    ds_read_b64_tr_b16 v[140:141], v18 offset:12288
    ds_read_b64_tr_b16 v[142:143], v18 offset:12800
    ds_read_b128 v[144:147], v15 offset:0
    ds_read_b128 v[148:151], v15 offset:32768
    s_waitcnt lgkmcnt(12)
    buffer_store_dwordx4 v[20:23], v3, s[24:27], s14 offen sc0 sc1
    s_branch L_p1_qk_m
L_p1_qk:
    v_mfma_f32_32x32x16_bf16 v[48:63], v[140:143], v[144:147], v[48:63]
    ds_read_b64_tr_b16 v[116:117], v18 offset:0
    ds_read_b64_tr_b16 v[118:119], v18 offset:512
    ds_read_b128 v[120:123], v13 offset:0
    v_mfma_f32_32x32x16_bf16 v[64:79], v[140:143], v[148:151], v[64:79]
    ds_read_b128 v[124:127], v13 offset:32768
    ds_read_b64_tr_b16 v[128:129], v18 offset:6144
    ds_read_b64_tr_b16 v[130:131], v18 offset:6656
    v_mfma_f32_32x32x16_bf16 v[48:63], v[152:155], v[156:159], v[48:63]
    ds_read_b128 v[132:135], v14 offset:0
    ds_read_b128 v[136:139], v14 offset:32768
    ds_read_b64_tr_b16 v[140:141], v18 offset:12288
    v_mfma_f32_32x32x16_bf16 v[64:79], v[152:155], v[160:163], v[64:79]
    ds_read_b64_tr_b16 v[142:143], v18 offset:12800
    ds_read_b128 v[144:147], v15 offset:0
    ds_read_b128 v[148:151], v15 offset:32768
L_p1_qk_m:
    s_waitcnt lgkmcnt(8)
    v_mfma_f32_32x32x16_bf16 v[48:63], v[116:119], v[120:123], v[48:63]
    ds_read_b64_tr_b16 v[152:153], v18 offset:18432
    ds_read_b64_tr_b16 v[154:155], v18 offset:18944
    ds_read_b128 v[156:159], v16 offset:0
    v_mfma_f32_32x32x16_bf16 v[64:79], v[116:119], v[124:127], v[64:79]
    ds_read_b128 v[160:163], v16 offset:32768
    s_waitcnt lgkmcnt(8)
    v_mfma_f32_32x32x16_bf16 v[48:63], v[128:131], v[132:135], v[48:63]
    v_xor_b32 v13, s31, v12
    v_add_u32 v18, s28, v17
    v_xor_b32 v14, 32, v13
    v_xor_b32 v15, 64, v13
    v_xor_b32 v16, 96, v13
    s_add_u32 s31, s31, 128
    s_and_b32 s31, s31, 0x3ff
    s_add_u32 s28, s28, 24704
    s_cmp_eq_u32 s28, 139648
    s_cselect_b32 s28, 65536, s28
    v_mfma_f32_32x32x16_bf16 v[64:79], v[128:131], v[136:139], v[64:79]
    s_sub_u32 s29, s29, 1
    s_cmp_lg_u32 s29, 5
    s_cbranch_scc1 L_p1_qk_b
    s_waitcnt vmcnt(0)
L_p1_qk_b:
    s_waitcnt lgkmcnt(0)
    s_barrier
    s_cmp_lg_u32 s29, 0
    s_cbranch_scc1 L_p1_qk
    v_mfma_f32_32x32x16_bf16 v[48:63], v[140:143], v[144:147], v[48:63]
    v_mfma_f32_32x32x16_bf16 v[64:79], v[140:143], v[148:151], v[64:79]
    v_mfma_f32_32x32x16_bf16 v[48:63], v[152:155], v[156:159], v[48:63]
    v_mfma_f32_32x32x16_bf16 v[64:79], v[152:155], v[160:163], v[64:79]
    v_sub_u32 v18, v18, v17
    v_add_u32 v18, v18, v10
    s_mov_b32 s29, 8
    ds_read_b64_tr_b16 v[116:117], v18 offset:0
    ds_read_b64_tr_b16 v[118:119], v18 offset:768
    ds_read_b128 v[120:123], v13 offset:0
    ds_read_b128 v[124:127], v13 offset:32768
    ds_read_b64_tr_b16 v[128:129], v18 offset:3072
    ds_read_b64_tr_b16 v[130:131], v18 offset:3840
    ds_read_b128 v[132:135], v14 offset:0
    ds_read_b128 v[136:139], v14 offset:32768
    ds_read_b64_tr_b16 v[140:141], v18 offset:6144
    ds_read_b64_tr_b16 v[142:143], v18 offset:6912
    ds_read_b128 v[144:147], v15 offset:0
    ds_read_b128 v[148:151], v15 offset:32768
    v_mul_f32 v48, v4, v48
    v_mul_f32 v49, v4, v49
    v_mul_f32 v50, v4, v50
    v_mul_f32 v51, v4, v51
    v_mul_f32 v52, v4, v52
    v_mul_f32 v53, v4, v53
    v_mul_f32 v54, v4, v54
    v_mul_f32 v55, v4, v55
    v_mul_f32 v56, v4, v56
    v_mul_f32 v57, v4, v57
    v_mul_f32 v58, v4, v58
    v_mul_f32 v59, v4, v59
    v_mul_f32 v60, v4, v60
    v_mul_f32 v61, v4, v61
    v_mul_f32 v62, v4, v62
    v_mul_f32 v63, v4, v63
    v_cvt_pk_bf16_f32 v20, v48, v49
    v_cvt_pk_bf16_f32 v21, v50, v51
    v_cvt_pk_bf16_f32 v22, v52, v53
    v_cvt_pk_bf16_f32 v23, v54, v55
    v_cvt_pk_bf16_f32 v24, v56, v57
    v_cvt_pk_bf16_f32 v25, v58, v59
    v_cvt_pk_bf16_f32 v26, v60, v61
    v_cvt_pk_bf16_f32 v27, v62, v63
    buffer_store_dwordx4 v[20:23], v3, s[24:27], s45 offen sc0 sc1
    buffer_store_dwordx4 v[24:27], v3, s[24:27], s46 offen sc0 sc1
    v_mul_f32 v64, v4, v64
    v_mul_f32 v65, v4, v65
    v_mul_f32 v66, v4, v66
    v_mul_f32 v67, v4, v67
    v_mul_f32 v68, v4, v68
    v_mul_f32 v69, v4, v69
    v_mul_f32 v70, v4, v70
    v_mul_f32 v71, v4, v71
    v_mul_f32 v72, v4, v72
    v_mul_f32 v73, v4, v73
    v_mul_f32 v74, v4, v74
    v_mul_f32 v75, v4, v75
    v_mul_f32 v76, v4, v76
    v_mul_f32 v77, v4, v77
    v_mul_f32 v78, v4, v78
    v_mul_f32 v79, v4, v79
    v_cvt_pk_bf16_f32 v28, v64, v65
    v_cvt_pk_bf16_f32 v29, v66, v67
    v_cvt_pk_bf16_f32 v30, v68, v69
    v_cvt_pk_bf16_f32 v31, v70, v71
    v_cvt_pk_bf16_f32 v32, v72, v73
    v_cvt_pk_bf16_f32 v33, v74, v75
    v_cvt_pk_bf16_f32 v34, v76, v77
    v_cvt_pk_bf16_f32 v35, v78, v79
    buffer_store_dwordx4 v[28:31], v19, s[24:27], s45 offen sc0 sc1
    buffer_store_dwordx4 v[32:35], v19, s[24:27], s46 offen sc0 sc1
    s_branch L_gu4_m
L_gu4:
    v_mfma_f32_32x32x16_bf16 v[80:95], v[140:143], v[144:147], v[80:95]
    ds_read_b64_tr_b16 v[116:117], v18 offset:0
    ds_read_b64_tr_b16 v[118:119], v18 offset:768
    ds_read_b128 v[120:123], v13 offset:0
    v_mfma_f32_32x32x16_bf16 v[96:111], v[140:143], v[148:151], v[96:111]
    ds_read_b128 v[124:127], v13 offset:32768
    ds_read_b64_tr_b16 v[128:129], v18 offset:3072
    ds_read_b64_tr_b16 v[130:131], v18 offset:3840
    v_mfma_f32_32x32x16_bf16 v[80:95], v[152:155], v[156:159], v[80:95]
    ds_read_b128 v[132:135], v14 offset:0
    ds_read_b128 v[136:139], v14 offset:32768
    ds_read_b64_tr_b16 v[140:141], v18 offset:6144
    v_mfma_f32_32x32x16_bf16 v[96:111], v[152:155], v[160:163], v[96:111]
    ds_read_b64_tr_b16 v[142:143], v18 offset:6912
    ds_read_b128 v[144:147], v15 offset:0
    ds_read_b128 v[148:151], v15 offset:32768
L_gu4_m:
    s_waitcnt lgkmcnt(8)
    v_mfma_f32_32x32x16_bf16 v[80:95], v[116:119], v[120:123], v[80:95]
    ds_read_b64_tr_b16 v[152:153], v18 offset:9216
    ds_read_b64_tr_b16 v[154:155], v18 offset:9984
    ds_read_b128 v[156:159], v16 offset:0
    v_mfma_f32_32x32x16_bf16 v[96:111], v[116:119], v[124:127], v[96:111]
    ds_read_b128 v[160:163], v16 offset:32768
    s_waitcnt lgkmcnt(8)
    v_mfma_f32_32x32x16_bf16 v[80:95], v[128:131], v[132:135], v[80:95]
    v_xor_b32 v13, s31, v12
    v_add_u32 v18, s28, v10
    v_xor_b32 v14, 32, v13
    v_xor_b32 v15, 64, v13
    v_xor_b32 v16, 96, v13
    s_add_u32 s31, s31, 128
    s_and_b32 s31, s31, 0x3ff
    s_add_u32 s28, s28, 24704
    s_cmp_eq_u32 s28, 139648
    s_cselect_b32 s28, 65536, s28
    v_mfma_f32_32x32x16_bf16 v[96:111], v[128:131], v[136:139], v[96:111]
    s_sub_u32 s29, s29, 1
    s_cmp_lg_u32 s29, 6
    s_cbranch_scc1 L_gu4_b
    s_waitcnt vmcnt(0)
L_gu4_b:
    s_waitcnt lgkmcnt(0)
    s_barrier
    s_cmp_lg_u32 s29, 0
    s_cbranch_scc1 L_gu4
    s_setprio 3
    v_mfma_f32_32x32x16_bf16 v[80:95], v[140:143], v[144:147], v[80:95]
    v_mfma_f32_32x32x16_bf16 v[96:111], v[140:143], v[148:151], v[96:111]
    v_mfma_f32_32x32x16_bf16 v[80:95], v[152:155], v[156:159], v[80:95]
    v_mfma_f32_32x32x16_bf16 v[96:111], v[152:155], v[160:163], v[96:111]
    s_branch L_p1_done
L_p1_v0:
    s_setprio 1
    ds_read_b128 v[120:123], v13 offset:0
    ds_read_b64_tr_b16 v[116:117], v18 offset:0
    ds_read_b64_tr_b16 v[118:119], v18 offset:512
    ds_read_b128 v[128:131], v14 offset:0
    ds_read_b64_tr_b16 v[124:125], v18 offset:6144
    ds_read_b64_tr_b16 v[126:127], v18 offset:6656
    ds_read_b128 v[136:139], v15 offset:0
    ds_read_b64_tr_b16 v[132:133], v18 offset:12288
    ds_read_b64_tr_b16 v[134:135], v18 offset:12800
    s_waitcnt lgkmcnt(9)
    buffer_store_dwordx4 v[20:23], v3, s[24:27], s14 offen sc0 sc1
    s_branch L_p1_v_m
L_p1_v:
    v_mfma_f32_32x32x16_bf16 v[48:63], v[136:139], v[132:135], v[48:63]
    ds_read_b128 v[120:123], v13 offset:0
    ds_read_b64_tr_b16 v[116:117], v18 offset:0
    ds_read_b64_tr_b16 v[118:119], v18 offset:512
    ds_read_b128 v[128:131], v14 offset:0
    v_mfma_f32_32x32x16_bf16 v[48:63], v[144:147], v[140:143], v[48:63]
    ds_read_b64_tr_b16 v[124:125], v18 offset:6144
    ds_read_b64_tr_b16 v[126:127], v18 offset:6656
    ds_read_b128 v[136:139], v15 offset:0
    ds_read_b64_tr_b16 v[132:133], v18 offset:12288
    ds_read_b64_tr_b16 v[134:135], v18 offset:12800
L_p1_v_m:
    s_waitcnt lgkmcnt(6)
    v_mfma_f32_32x32x16_bf16 v[48:63], v[120:123], v[116:119], v[48:63]
    ds_read_b128 v[144:147], v16 offset:0
    ds_read_b64_tr_b16 v[140:141], v18 offset:18432
    ds_read_b64_tr_b16 v[142:143], v18 offset:18944
    s_waitcnt lgkmcnt(6)
    v_mfma_f32_32x32x16_bf16 v[48:63], v[128:131], v[124:127], v[48:63]
    v_xor_b32 v13, s31, v12
    v_add_u32 v18, s28, v17
    v_xor_b32 v14, 32, v13
    v_xor_b32 v15, 64, v13
    v_xor_b32 v16, 96, v13
    s_add_u32 s31, s31, 128
    s_and_b32 s31, s31, 0x3ff
    s_add_u32 s28, s28, 24704
    s_cmp_eq_u32 s28, 139648
    s_cselect_b32 s28, 65536, s28
    s_sub_u32 s29, s29, 1
    s_cmp_lg_u32 s29, 5
    s_cbranch_scc1 L_p1_v_b
    s_waitcnt vmcnt(0)
L_p1_v_b:
    s_waitcnt lgkmcnt(0)
    s_barrier
    s_cmp_lg_u32 s29, 0
    s_cbranch_scc1 L_p1_v
    v_mfma_f32_32x32x16_bf16 v[48:63], v[136:139], v[132:135], v[48:63]
    v_mfma_f32_32x32x16_bf16 v[48:63], v[144:147], v[140:143], v[48:63]
    v_sub_u32 v18, v18, v17
    v_add_u32 v18, v18, v10
    s_mov_b32 s29, 8
    ds_read_b128 v[120:123], v13 offset:0
    ds_read_b64_tr_b16 v[116:117], v18 offset:0
    ds_read_b64_tr_b16 v[118:119], v18 offset:768
    ds_read_b128 v[128:131], v14 offset:0
    ds_read_b64_tr_b16 v[124:125], v18 offset:3072
    ds_read_b64_tr_b16 v[126:127], v18 offset:3840
    ds_read_b128 v[136:139], v15 offset:0
    ds_read_b64_tr_b16 v[132:133], v18 offset:6144
    ds_read_b64_tr_b16 v[134:135], v18 offset:6912
    v_cvt_pk_bf16_f32 v20, v48, v49
    v_cvt_pk_bf16_f32 v21, v50, v51
    v_cvt_pk_bf16_f32 v22, v52, v53
    v_cvt_pk_bf16_f32 v23, v54, v55
    v_cvt_pk_bf16_f32 v24, v56, v57
    v_cvt_pk_bf16_f32 v25, v58, v59
    v_cvt_pk_bf16_f32 v26, v60, v61
    v_cvt_pk_bf16_f32 v27, v62, v63
    buffer_store_dwordx4 v[20:23], v115, s[24:27], s45 offen offset:1024 sc0 sc1
    buffer_store_dwordx4 v[24:27], v115, s[24:27], s45 offen offset:1536 sc0 sc1
    s_branch L_gu3_m
L_gu3:
    v_mfma_f32_32x32x16_bf16 v[80:95], v[132:135], v[136:139], v[80:95]
    ds_read_b128 v[120:123], v13 offset:0
    ds_read_b64_tr_b16 v[116:117], v18 offset:0
    ds_read_b64_tr_b16 v[118:119], v18 offset:768
    ds_read_b128 v[128:131], v14 offset:0
    v_mfma_f32_32x32x16_bf16 v[80:95], v[140:143], v[144:147], v[80:95]
    ds_read_b64_tr_b16 v[124:125], v18 offset:3072
    ds_read_b64_tr_b16 v[126:127], v18 offset:3840
    ds_read_b128 v[136:139], v15 offset:0
    ds_read_b64_tr_b16 v[132:133], v18 offset:6144
    ds_read_b64_tr_b16 v[134:135], v18 offset:6912
L_gu3_m:
    s_waitcnt lgkmcnt(6)
    v_mfma_f32_32x32x16_bf16 v[80:95], v[116:119], v[120:123], v[80:95]
    ds_read_b128 v[144:147], v16 offset:0
    ds_read_b64_tr_b16 v[140:141], v18 offset:9216
    ds_read_b64_tr_b16 v[142:143], v18 offset:9984
    s_waitcnt lgkmcnt(6)
    v_mfma_f32_32x32x16_bf16 v[80:95], v[124:127], v[128:131], v[80:95]
    v_xor_b32 v13, s31, v12
    v_add_u32 v18, s28, v10
    v_xor_b32 v14, 32, v13
    v_xor_b32 v15, 64, v13
    v_xor_b32 v16, 96, v13
    s_add_u32 s31, s31, 128
    s_and_b32 s31, s31, 0x3ff
    s_add_u32 s28, s28, 24704
    s_cmp_eq_u32 s28, 139648
    s_cselect_b32 s28, 65536, s28
    s_sub_u32 s29, s29, 1
    s_cmp_lg_u32 s29, 6
    s_cbranch_scc1 L_gu3_b
    s_waitcnt vmcnt(0)
L_gu3_b:
    s_waitcnt lgkmcnt(0)
    s_barrier
    s_cmp_lg_u32 s29, 0
    s_cbranch_scc1 L_gu3
    s_setprio 3
    v_mfma_f32_32x32x16_bf16 v[80:95], v[132:135], v[136:139], v[80:95]
    v_mfma_f32_32x32x16_bf16 v[80:95], v[140:143], v[144:147], v[80:95]
L_p1_done:
    s_xor_b32 s38, s55, 1024
    buffer_load_dwordx4 v[4:7], v3, s[24:27], s55 offen sc1
    buffer_load_dwordx4 v[112:115], v3, s[24:27], s38 offen sc1
    s_mov_b32 m0, s53
    s_add_u32 s37, s51, s52
    buffer_load_dwordx4 v3, s[24:27], s37 offen sc1 lds
    buffer_load_dwordx4 v3, s[24:27], s37 offen offset:1024 sc1 lds
    s_add_u32 s53, s53, 16384
    s_and_b32 s53, s53, 0xffff
    s_add_u32 s52, s52, 16384
    v_mov_b32 v10, v11
    v_mov_b64 v[20:21], v[10:11]
    v_mov_b64 v[22:23], v[10:11]
    v_mov_b64 v[24:25], v[10:11]
    v_mov_b64 v[26:27], v[10:11]
    v_mov_b64 v[28:29], v[10:11]
    v_mov_b64 v[30:31], v[10:11]
    v_mov_b64 v[32:33], v[10:11]
    v_mov_b64 v[34:35], v[10:11]
    v_pk_mul_f32 v[48:49], v[80:81], v[80:81]
    v_pk_mul_f32 v[50:51], v[82:83], v[82:83]
    v_pk_mul_f32 v[52:53], v[84:85], v[84:85]
    v_pk_mul_f32 v[54:55], v[86:87], v[86:87]
    v_pk_fma_f32 v[48:49], v[48:49], v[38:39], v[36:37] op_sel_hi:[1,0,0]
    v_pk_fma_f32 v[50:51], v[50:51], v[38:39], v[36:37] op_sel_hi:[1,0,0]
    v_pk_fma_f32 v[52:53], v[52:53], v[38:39], v[36:37] op_sel_hi:[1,0,0]
    v_pk_fma_f32 v[54:55], v[54:55], v[38:39], v[36:37] op_sel_hi:[1,0,0]
    v_pk_mul_f32 v[48:49], v[48:49], v[80:81]
    v_pk_mul_f32 v[50:51], v[50:51], v[82:83]
    v_pk_mul_f32 v[52:53], v[52:53], v[84:85]
    v_pk_mul_f32 v[54:55], v[54:55], v[86:87]
    v_exp_f32 v48, v48
    v_exp_f32 v49, v49
    v_exp_f32 v50, v50
    v_exp_f32 v51, v51
    v_exp_f32 v52, v52
    v_exp_f32 v53, v53
    v_exp_f32 v54, v54
    v_exp_f32 v55, v55
    v_pk_mul_f32 v[80:81], v[80:81], v[88:89]
    v_pk_mul_f32 v[82:83], v[82:83], v[90:91]
    v_pk_mul_f32 v[84:85], v[84:85], v[92:93]
    v_pk_mul_f32 v[86:87], v[86:87], v[94:95]
    v_pk_add_f32 v[48:49], v[48:49], 1.0 op_sel_hi:[1,0]
    v_pk_add_f32 v[50:51], v[50:51], 1.0 op_sel_hi:[1,0]
    v_pk_add_f32 v[52:53], v[52:53], 1.0 op_sel_hi:[1,0]
    v_pk_add_f32 v[54:55], v[54:55], 1.0 op_sel_hi:[1,0]
    v_rcp_f32 v48, v48
    v_rcp_f32 v49, v49
    v_rcp_f32 v50, v50
    v_rcp_f32 v51, v51
    v_rcp_f32 v52, v52
    v_rcp_f32 v53, v53
    v_rcp_f32 v54, v54
    v_rcp_f32 v55, v55
    s_nop 0
    v_pk_mul_f32 v[80:81], v[80:81], v[48:49]
    v_pk_mul_f32 v[82:83], v[82:83], v[50:51]
    v_pk_mul_f32 v[84:85], v[84:85], v[52:53]
    v_pk_mul_f32 v[86:87], v[86:87], v[54:55]
    v_cvt_pk_bf16_f32 v56, v80, v81
    v_cvt_pk_bf16_f32 v57, v82, v83
    v_cvt_pk_bf16_f32 v58, v84, v85
    v_cvt_pk_bf16_f32 v59, v86, v87
    buffer_store_dwordx4 v[56:59], v3, s[24:27], s12 offen sc0 sc1
    v_mov_b64 v[80:81], 0
    v_mov_b64 v[82:83], 0
    v_mov_b64 v[84:85], 0
    v_mov_b64 v[86:87], 0
    v_mov_b64 v[88:89], 0
    v_mov_b64 v[90:91], 0
    v_mov_b64 v[92:93], 0
    v_mov_b64 v[94:95], 0
    s_cmp_ge_u32 s36, 4
    s_cbranch_scc1 L_g_done
    v_pk_mul_f32 v[60:61], v[96:97], v[96:97]
    v_pk_mul_f32 v[62:63], v[98:99], v[98:99]
    v_pk_mul_f32 v[64:65], v[100:101], v[100:101]
    v_pk_mul_f32 v[66:67], v[102:103], v[102:103]
    v_pk_fma_f32 v[60:61], v[60:61], v[38:39], v[36:37] op_sel_hi:[1,0,0]
    v_pk_fma_f32 v[62:63], v[62:63], v[38:39], v[36:37] op_sel_hi:[1,0,0]
    v_pk_fma_f32 v[64:65], v[64:65], v[38:39], v[36:37] op_sel_hi:[1,0,0]
    v_pk_fma_f32 v[66:67], v[66:67], v[38:39], v[36:37] op_sel_hi:[1,0,0]
    v_pk_mul_f32 v[60:61], v[60:61], v[96:97]
    v_pk_mul_f32 v[62:63], v[62:63], v[98:99]
    v_pk_mul_f32 v[64:65], v[64:65], v[100:101]
    v_pk_mul_f32 v[66:67], v[66:67], v[102:103]
    v_exp_f32 v60, v60
    v_exp_f32 v61, v61
    v_exp_f32 v62, v62
    v_exp_f32 v63, v63
    v_exp_f32 v64, v64
    v_exp_f32 v65, v65
    v_exp_f32 v66, v66
    v_exp_f32 v67, v67
    v_pk_mul_f32 v[96:97], v[96:97], v[104:105]
    v_pk_mul_f32 v[98:99], v[98:99], v[106:107]
    v_pk_mul_f32 v[100:101], v[100:101], v[108:109]
    v_pk_mul_f32 v[102:103], v[102:103], v[110:111]
    v_pk_add_f32 v[60:61], v[60:61], 1.0 op_sel_hi:[1,0]
    v_pk_add_f32 v[62:63], v[62:63], 1.0 op_sel_hi:[1,0]
    v_pk_add_f32 v[64:65], v[64:65], 1.0 op_sel_hi:[1,0]
    v_pk_add_f32 v[66:67], v[66:67], 1.0 op_sel_hi:[1,0]
    v_rcp_f32 v60, v60
    v_rcp_f32 v61, v61
    v_rcp_f32 v62, v62
    v_rcp_f32 v63, v63
    v_rcp_f32 v64, v64
    v_rcp_f32 v65, v65
    v_rcp_f32 v66, v66
    v_rcp_f32 v67, v67
    s_nop 0
    v_pk_mul_f32 v[96:97], v[96:97], v[60:61]
    v_pk_mul_f32 v[98:99], v[98:99], v[62:63]
    v_pk_mul_f32 v[100:101], v[100:101], v[64:65]
    v_pk_mul_f32 v[102:103], v[102:103], v[66:67]
    v_cvt_pk_bf16_f32 v68, v96, v97
    v_cvt_pk_bf16_f32 v69, v98, v99
    v_cvt_pk_bf16_f32 v70, v100, v101
    v_cvt_pk_bf16_f32 v71, v102, v103
    buffer_store_dwordx4 v[68:71], v3, s[24:27], s13 offen sc0 sc1
    v_mov_b64 v[96:97], 0
    v_mov_b64 v[98:99], 0
    v_mov_b64 v[100:101], 0
    v_mov_b64 v[102:103], 0
    v_mov_b64 v[104:105], 0
    v_mov_b64 v[106:107], 0
    v_mov_b64 v[108:109], 0
    v_mov_b64 v[110:111], 0
L_g_done:
    s_mov_b32 m0, s53
    s_add_u32 s37, s51, s52
    buffer_load_dwordx4 v3, s[24:27], s37 offen sc1 lds
    buffer_load_dwordx4 v3, s[24:27], s37 offen offset:1024 sc1 lds
    s_add_u32 s53, s53, 16384
    s_and_b32 s53, s53, 0xffff
    s_add_u32 s52, s52, 16384
    s_waitcnt vmcnt(3)
    s_mov_b64 exec, 1
    ds_add_u32 v44, v45 offset:0
    s_mov_b64 exec, -1
    s_mov_b32 s62, 0x200000
L_a_first:
    ds_read_b32 v46, v44 offset:28
    s_waitcnt lgkmcnt(0)
    v_readfirstlane_b32 s37, v46
    s_nop 0
    s_cmp_ge_u32 s37, 4
    s_cbranch_scc1 L_a_first_ok
    s_sleep 1
    s_sub_u32 s62, s62, 1
    s_cbranch_scc0 L_a_first
L_a_first_ok:
    ds_read_b128 v[12:15], v8 offset:0
    s_mov_b64 exec, s[58:59]
    ds_read_b128 v[20:23], v9 offset:1024
    ds_read_b128 v[24:27], v9 offset:1536
    s_mov_b64 exec, -1
    ds_read_b128 v[16:19], v8 offset:2048
    s_mov_b32 s45, 0
    s_mov_b32 s46, 8
    s_waitcnt lgkmcnt(3)
    v_mfma_f32_32x32x16_bf16 v[48:63], v[12:15], v[4:7], 0
    s_setprio 0
    s_nop 8
L_at_loop:
    s_setprio 2
    s_waitcnt lgkmcnt(0)
    v_mfma_f32_32x32x16_bf16 v[64:79], v[12:15], v[112:115], 0
    v_exp_f32 v48, v48
    v_exp_f32 v49, v49
    v_exp_f32 v50, v50
    v_exp_f32 v51, v51
    v_mfma_f32_32x32x16_bf16 v[96:111], v[32:35], v[40:43], v[96:111]
    ds_read_b128 v[12:15], v8 offset:4096
    s_mov_b64 exec, s[58:59]
    ds_read_b128 v[28:31], v9 offset:3072
    ds_read_b128 v[32:35], v9 offset:3584
    s_mov_b64 exec, -1
    v_cvt_pk_bf16_f32 v36, v48, v49
    v_exp_f32 v52, v52
    v_cvt_pk_bf16_f32 v37, v50, v51
    v_exp_f32 v53, v53
    v_exp_f32 v54, v54
    v_exp_f32 v55, v55
    v_cvt_pk_bf16_f32 v38, v52, v53
    v_exp_f32 v56, v56
    v_cvt_pk_bf16_f32 v39, v54, v55
    v_exp_f32 v57, v57
    v_exp_f32 v58, v58
    v_mfma_f32_32x32x16_bf16 v[80:95], v[20:23], v[36:39], v[80:95]
    v_exp_f32 v59, v59
    v_exp_f32 v60, v60
    v_cvt_pk_bf16_f32 v40, v56, v57
    v_exp_f32 v61, v61
    v_cvt_pk_bf16_f32 v41, v58, v59
    v_exp_f32 v62, v62
    v_exp_f32 v63, v63
    v_cvt_pk_bf16_f32 v42, v60, v61
    v_cvt_pk_bf16_f32 v43, v62, v63
    v_mfma_f32_32x32x16_bf16 v[48:63], v[16:19], v[4:7], 0
    v_exp_f32 v64, v64
    v_exp_f32 v65, v65
    v_exp_f32 v66, v66
    v_exp_f32 v67, v67
    v_mfma_f32_32x32x16_bf16 v[80:95], v[24:27], v[40:43], v[80:95]
    v_cvt_pk_bf16_f32 v36, v64, v65
    v_exp_f32 v68, v68
    v_cvt_pk_bf16_f32 v37, v66, v67
    v_exp_f32 v69, v69
    v_exp_f32 v70, v70
    v_exp_f32 v71, v71
    v_cvt_pk_bf16_f32 v38, v68, v69
    v_exp_f32 v72, v72
    v_cvt_pk_bf16_f32 v39, v70, v71
    v_exp_f32 v73, v73
    v_exp_f32 v74, v74
    v_mfma_f32_32x32x16_bf16 v[96:111], v[20:23], v[36:39], v[96:111]
    v_exp_f32 v75, v75
    v_exp_f32 v76, v76
    v_cvt_pk_bf16_f32 v40, v72, v73
    v_exp_f32 v77, v77
    v_cvt_pk_bf16_f32 v41, v74, v75
    v_exp_f32 v78, v78
    v_exp_f32 v79, v79
    v_cvt_pk_bf16_f32 v42, v76, v77
    v_cvt_pk_bf16_f32 v43, v78, v79
    s_setprio 1
    s_waitcnt lgkmcnt(0)
    v_mfma_f32_32x32x16_bf16 v[64:79], v[16:19], v[112:115], 0
    v_exp_f32 v48, v48
    v_exp_f32 v49, v49
    v_exp_f32 v50, v50
    v_exp_f32 v51, v51
    v_mfma_f32_32x32x16_bf16 v[96:111], v[24:27], v[40:43], v[96:111]
    ds_read_b128 v[16:19], v8 offset:6144
    s_mov_b64 exec, s[58:59]
    ds_read_b128 v[20:23], v9 offset:5120
    ds_read_b128 v[24:27], v9 offset:5632
    s_mov_b64 exec, -1
    v_cvt_pk_bf16_f32 v36, v48, v49
    v_exp_f32 v52, v52
    v_cvt_pk_bf16_f32 v37, v50, v51
    v_exp_f32 v53, v53
    v_exp_f32 v54, v54
    v_exp_f32 v55, v55
    v_cvt_pk_bf16_f32 v38, v52, v53
    v_exp_f32 v56, v56
    v_cvt_pk_bf16_f32 v39, v54, v55
    v_exp_f32 v57, v57
    v_exp_f32 v58, v58
    v_mfma_f32_32x32x16_bf16 v[80:95], v[28:31], v[36:39], v[80:95]
    v_exp_f32 v59, v59
    v_exp_f32 v60, v60
    v_cvt_pk_bf16_f32 v40, v56, v57
    v_exp_f32 v61, v61
    v_cvt_pk_bf16_f32 v41, v58, v59
    v_exp_f32 v62, v62
    v_exp_f32 v63, v63
    v_cvt_pk_bf16_f32 v42, v60, v61
    v_cvt_pk_bf16_f32 v43, v62, v63
    v_mfma_f32_32x32x16_bf16 v[48:63], v[12:15], v[4:7], 0
    v_exp_f32 v64, v64
    v_exp_f32 v65, v65
    v_exp_f32 v66, v66
    v_exp_f32 v67, v67
    v_mfma_f32_32x32x16_bf16 v[80:95], v[32:35], v[40:43], v[80:95]
    v_cvt_pk_bf16_f32 v36, v64, v65
    v_exp_f32 v68, v68
    ds_read_b32 v46, v44
    v_add_u32 v8, 16384, v8
    v_and_b32 v8, 0xffff, v8
    v_cvt_pk_bf16_f32 v37, v66, v67
    v_exp_f32 v69, v69
    v_exp_f32 v70, v70
    v_exp_f32 v71, v71
    v_cvt_pk_bf16_f32 v38, v68, v69
    v_exp_f32 v72, v72
    v_cvt_pk_bf16_f32 v39, v70, v71
    v_exp_f32 v73, v73
    v_exp_f32 v74, v74
    v_mfma_f32_32x32x16_bf16 v[96:111], v[28:31], v[36:39], v[96:111]
    v_exp_f32 v75, v75
    v_exp_f32 v76, v76
    v_cvt_pk_bf16_f32 v40, v72, v73
    v_exp_f32 v77, v77
    v_cvt_pk_bf16_f32 v41, v74, v75
    v_exp_f32 v78, v78
    v_exp_f32 v79, v79
    v_cvt_pk_bf16_f32 v42, v76, v77
    v_cvt_pk_bf16_f32 v43, v78, v79
    s_setprio 0
    s_waitcnt lgkmcnt(0)
    v_mfma_f32_32x32x16_bf16 v[64:79], v[12:15], v[112:115], 0
    v_exp_f32 v48, v48
    v_readfirstlane_b32 s37, v46
    v_exp_f32 v49, v49
    s_cmp_ge_u32 s37, s46
    s_cbranch_scc0 L_at_slow
L_at_back:
    v_exp_f32 v50, v50
    v_exp_f32 v51, v51
    v_mfma_f32_32x32x16_bf16 v[96:111], v[32:35], v[40:43], v[96:111]
    ds_read_b128 v[12:15], v8 offset:0
    s_mov_b64 exec, s[58:59]
    ds_read_b128 v[28:31], v9 offset:7168
    ds_read_b128 v[32:35], v9 offset:7680
    s_mov_b64 exec, -1
    v_cvt_pk_bf16_f32 v36, v48, v49
    v_exp_f32 v52, v52
    v_cvt_pk_bf16_f32 v37, v50, v51
    v_exp_f32 v53, v53
    v_exp_f32 v54, v54
    v_exp_f32 v55, v55
    v_cvt_pk_bf16_f32 v38, v52, v53
    v_exp_f32 v56, v56
    v_cvt_pk_bf16_f32 v39, v54, v55
    v_exp_f32 v57, v57
    v_exp_f32 v58, v58
    v_mfma_f32_32x32x16_bf16 v[80:95], v[20:23], v[36:39], v[80:95]
    v_exp_f32 v59, v59
    v_exp_f32 v60, v60
    v_cvt_pk_bf16_f32 v40, v56, v57
    v_exp_f32 v61, v61
    v_cvt_pk_bf16_f32 v41, v58, v59
    v_exp_f32 v62, v62
    v_exp_f32 v63, v63
    v_cvt_pk_bf16_f32 v42, v60, v61
    v_cvt_pk_bf16_f32 v43, v62, v63
    v_mfma_f32_32x32x16_bf16 v[48:63], v[16:19], v[4:7], 0
    v_exp_f32 v64, v64
    v_exp_f32 v65, v65
    v_exp_f32 v66, v66
    v_exp_f32 v67, v67
    v_mfma_f32_32x32x16_bf16 v[80:95], v[24:27], v[40:43], v[80:95]
    v_cvt_pk_bf16_f32 v36, v64, v65
    v_exp_f32 v68, v68
    v_add_u32 v9, 16384, v9
    v_and_b32 v9, 0xffff, v9
    s_waitcnt vmcnt(0)
    s_cmp_ge_u32 s45, 5
    s_cbranch_scc1 L_at_nodma
    s_setprio 3
    s_mov_b32 m0, s53
    s_add_u32 s37, s51, s52
    buffer_load_dwordx4 v3, s[24:27], s37 offen sc1 lds
    buffer_load_dwordx4 v3, s[24:27], s37 offen offset:1024 sc1 lds
    s_add_u32 s53, s53, 16384
    s_and_b32 s53, s53, 0xffff
    s_add_u32 s52, s52, 16384
    s_setprio 0
L_at_nodma:
    v_cvt_pk_bf16_f32 v37, v66, v67
    v_exp_f32 v69, v69
    v_exp_f32 v70, v70
    v_exp_f32 v71, v71
    v_cvt_pk_bf16_f32 v38, v68, v69
    v_exp_f32 v72, v72
    v_cvt_pk_bf16_f32 v39, v70, v71
    v_exp_f32 v73, v73
    v_exp_f32 v74, v74
    v_mfma_f32_32x32x16_bf16 v[96:111], v[20:23], v[36:39], v[96:111]
    v_exp_f32 v75, v75
    v_exp_f32 v76, v76
    v_cvt_pk_bf16_f32 v40, v72, v73
    v_exp_f32 v77, v77
    v_cvt_pk_bf16_f32 v41, v74, v75
    v_exp_f32 v78, v78
    v_exp_f32 v79, v79
    v_cvt_pk_bf16_f32 v42, v76, v77
    v_cvt_pk_bf16_f32 v43, v78, v79
    s_waitcnt lgkmcnt(0)
    v_mfma_f32_32x32x16_bf16 v[64:79], v[16:19], v[112:115], 0
    v_exp_f32 v48, v48
    v_exp_f32 v49, v49
    v_exp_f32 v50, v50
    v_exp_f32 v51, v51
    v_mfma_f32_32x32x16_bf16 v[96:111], v[24:27], v[40:43], v[96:111]
    ds_read_b128 v[16:19], v8 offset:2048
    s_mov_b64 exec, s[58:59]
    ds_read_b128 v[20:23], v9 offset:1024
    ds_read_b128 v[24:27], v9 offset:1536
    s_mov_b64 exec, -1
    v_cvt_pk_bf16_f32 v36, v48, v49
    v_exp_f32 v52, v52
    s_mov_b64 exec, 1
    ds_add_u32 v44, v45 offset:0
    s_mov_b64 exec, -1
    v_cvt_pk_bf16_f32 v37, v50, v51
    v_exp_f32 v53, v53
    v_exp_f32 v54, v54
    v_exp_f32 v55, v55
    v_cvt_pk_bf16_f32 v38, v52, v53
    v_exp_f32 v56, v56
    v_cvt_pk_bf16_f32 v39, v54, v55
    v_exp_f32 v57, v57
    v_exp_f32 v58, v58
    v_mfma_f32_32x32x16_bf16 v[80:95], v[28:31], v[36:39], v[80:95]
    v_exp_f32 v59, v59
    v_exp_f32 v60, v60
    v_cvt_pk_bf16_f32 v40, v56, v57
    v_exp_f32 v61, v61
    v_cvt_pk_bf16_f32 v41, v58, v59
    v_exp_f32 v62, v62
    v_exp_f32 v63, v63
    v_cvt_pk_bf16_f32 v42, v60, v61
    v_cvt_pk_bf16_f32 v43, v62, v63
    v_mfma_f32_32x32x16_bf16 v[48:63], v[12:15], v[4:7], 0
    v_exp_f32 v64, v64
    v_exp_f32 v65, v65
    v_exp_f32 v66, v66
    v_exp_f32 v67, v67
    v_mfma_f32_32x32x16_bf16 v[80:95], v[32:35], v[40:43], v[80:95]
    v_cvt_pk_bf16_f32 v36, v64, v65
    v_exp_f32 v68, v68
    v_cvt_pk_bf16_f32 v37, v66, v67
    v_exp_f32 v69, v69
    v_exp_f32 v70, v70
    v_exp_f32 v71, v71
    v_cvt_pk_bf16_f32 v38, v68, v69
    v_exp_f32 v72, v72
    v_cvt_pk_bf16_f32 v39, v70, v71
    v_exp_f32 v73, v73
    v_exp_f32 v74, v74
    v_mfma_f32_32x32x16_bf16 v[96:111], v[28:31], v[36:39], v[96:111]
    v_exp_f32 v75, v75
    v_exp_f32 v76, v76
    v_cvt_pk_bf16_f32 v40, v72, v73
    v_exp_f32 v77, v77
    v_cvt_pk_bf16_f32 v41, v74, v75
    v_exp_f32 v78, v78
    v_exp_f32 v79, v79
    v_cvt_pk_bf16_f32 v42, v76, v77
    s_add_u32 s46, s46, 8
    s_add_u32 s45, s45, 1
    s_cmp_lt_u32 s45, 8
    v_cvt_pk_bf16_f32 v43, v78, v79
    s_cbranch_scc1 L_at_loop
    s_nop 0
    v_mfma_f32_32x32x16_bf16 v[96:111], v[32:35], v[40:43], v[96:111]
    s_lshl_b32 s37, s36, 12
    s_add_u32 s37, s37, 16384
    v_add_u32 v10, s37, v3
    v_xor_b32 v11, 0xc000, v10
    s_and_b32 s38, s36, 3
    s_lshl_b32 s57, s38, 2
    s_mul_i32 s39, s50, 147456
    s_lshl_b32 s38, s49, 10
    s_add_u32 s39, s39, s38
    s_add_u32 s39, s39, 8388608
    s_lshr_b32 s40, s50, 3
    s_lshl_b32 s40, s40, 5
    s_add_u32 s40, s40, s49
    s_lshl_b32 s40, s40, 7
    s_add_u32 s40, s40, 33816576
    ds_write_b128 v10, v[96:99]
    ds_write_b128 v10, v[100:103] offset:1024
    ds_write_b32 v10, v104 offset:2048
    s_waitcnt lgkmcnt(0)
    v_add_u32 v12, s57, v44
    s_mov_b64 exec, 1
    ds_add_u32 v12, v45 offset:8
    s_mov_b64 exec, -1
    s_mov_b32 s62, 0x200000
L_a_pair:
    ds_read_b32 v46, v12 offset:8
    s_waitcnt lgkmcnt(0)
    v_readfirstlane_b32 s37, v46
    s_nop 0
    s_cmp_ge_u32 s37, 2
    s_cbranch_scc1 L_a_pair_ok
    s_sleep 1
    s_sub_u32 s62, s62, 1
    s_cbranch_scc0 L_a_pair
L_a_pair_ok:
    ds_read_b128 v[48:51], v11
    ds_read_b128 v[52:55], v11 offset:1024
    ds_read_b32 v56, v11 offset:2048
    s_waitcnt lgkmcnt(0)
    v_add_f32 v88, v88, v56
    v_add_f32 v87, v87, v55
    v_add_f32 v86, v86, v54
    v_add_f32 v85, v85, v53
    v_add_f32 v84, v84, v52
    v_add_f32 v83, v83, v51
    v_add_f32 v82, v82, v50
    v_add_f32 v81, v81, v49
    v_add_f32 v80, v80, v48
    v_cmp_nle_f32 vcc, 0x21800000, v88
    s_nop 1
    s_mov_b64 s[56:57], vcc
    v_cmp_nge_f32 vcc, 0x5d800000, v88
    s_nop 1
    s_or_b64 vcc, vcc, s[56:57]
    s_cbranch_vccnz L_a_fallback
L_a_fin:
    s_setprio 3
    v_rcp_f32 v10, v88
    s_nop 0
    v_mul_f32 v80, v80, v10
    v_mul_f32 v81, v81, v10
    v_mul_f32 v82, v82, v10
    v_mul_f32 v83, v83, v10
    v_mul_f32 v84, v84, v10
    v_mul_f32 v85, v85, v10
    v_mul_f32 v86, v86, v10
    v_mul_f32 v87, v87, v10
    v_cvt_pk_bf16_f32 v36, v80, v81
    v_cvt_pk_bf16_f32 v37, v82, v83
    v_cvt_pk_bf16_f32 v38, v84, v85
    v_cvt_pk_bf16_f32 v39, v86, v87
    buffer_store_dwordx4 v[36:39], v3, s[24:27], s39 offen sc0 sc1
    s_waitcnt vmcnt(0)
    s_mov_b64 exec, 1
    ds_add_rtn_u32 v46, v44, v45 offset:32
    s_waitcnt lgkmcnt(0)
    v_readfirstlane_b32 s37, v46
    s_mov_b64 exec, -1
    s_cmp_lg_u32 s37, 7
    s_cbranch_scc1 L_a_exit
    s_mov_b64 exec, 1
    buffer_store_dwordx2 v[166:167], v3, s[24:27], s40 offen sc0 sc1
    s_mov_b64 exec, -1
L_a_exit:
    s_endpgm
L_at_slow:
    s_mov_b32 s62, 0x200000
L_at_spin:
    ds_read_b32 v46, v44 offset:0
    s_waitcnt lgkmcnt(0)
    v_readfirstlane_b32 s37, v46
    s_nop 0
    s_cmp_ge_u32 s37, s46
    s_cbranch_scc1 L_at_spin_ok
    s_sleep 1
    s_sub_u32 s62, s62, 1
    s_cbranch_scc0 L_at_spin
L_at_spin_ok:
    s_branch L_at_back
L_a_fallback:
    v_mov_b32 v10, 0xff800000
    s_mov_b32 s37, s54
    s_mov_b32 s45, 64
L_fb1:
    buffer_load_dwordx4 v[12:15], v3, s[24:27], s37 offen sc1
    s_waitcnt vmcnt(0)
    v_mfma_f32_32x32x16_bf16 v[48:63], v[12:15], v[4:7], 0
    s_nop 11
    v_max3_f32 v10, v10, v48, v49
    v_max3_f32 v10, v10, v50, v51
    v_max3_f32 v10, v10, v52, v53
    v_max3_f32 v10, v10, v54, v55
    v_max3_f32 v10, v10, v56, v57
    v_max3_f32 v10, v10, v58, v59
    v_max3_f32 v10, v10, v60, v61
    v_max3_f32 v10, v10, v62, v63
    s_add_u32 s37, s37, 2048
    s_sub_u32 s45, s45, 1
    s_cmp_lg_u32 s45, 0
    s_cbranch_scc1 L_fb1
    v_mov_b32 v11, v10
    s_nop 1
    v_permlane32_swap_b32 v10, v11
    v_max_f32 v10, v10, v11
    v_sub_f32 v96, 0, v10
    v_sub_f32 v97, 0, v10
    v_sub_f32 v98, 0, v10
    v_sub_f32 v99, 0, v10
    v_sub_f32 v100, 0, v10
    v_sub_f32 v101, 0, v10
    v_sub_f32 v102, 0, v10
    v_sub_f32 v103, 0, v10
    v_sub_f32 v104, 0, v10
    v_sub_f32 v105, 0, v10
    v_sub_f32 v106, 0, v10
    v_sub_f32 v107, 0, v10
    v_sub_f32 v108, 0, v10
    v_sub_f32 v109, 0, v10
    v_sub_f32 v110, 0, v10
    v_sub_f32 v111, 0, v10
    v_mov_b32 v80, 0
    v_mov_b32 v81, 0
    v_mov_b32 v82, 0
    v_mov_b32 v83, 0
    v_mov_b32 v84, 0
    v_mov_b32 v85, 0
    v_mov_b32 v86, 0
    v_mov_b32 v87, 0
    v_mov_b32 v88, 0
    v_mov_b32 v89, 0
    v_mov_b32 v90, 0
    v_mov_b32 v91, 0
    v_mov_b32 v92, 0
    v_mov_b32 v93, 0
    v_mov_b32 v94, 0
    v_mov_b32 v95, 0
    s_mov_b32 s37, s54
    s_mov_b32 s45, 64
L_fb2:
    buffer_load_dwordx4 v[12:15], v3, s[24:27], s37 offen sc1
    s_mov_b64 exec, s[58:59]
    buffer_load_dwordx4 v[20:23], v47, s[24:27], s37 offen offset:1024 sc1
    buffer_load_dwordx4 v[24:27], v47, s[24:27], s37 offen offset:1536 sc1
    s_mov_b64 exec, -1
    s_waitcnt vmcnt(0)
    v_mfma_f32_32x32x16_bf16 v[48:63], v[12:15], v[4:7], v[96:111]
    s_nop 11
    v_exp_f32 v48, v48
    v_exp_f32 v49, v49
    v_exp_f32 v50, v50
    v_exp_f32 v51, v51
    v_exp_f32 v52, v52
    v_exp_f32 v53, v53
    v_exp_f32 v54, v54
    v_exp_f32 v55, v55
    v_exp_f32 v56, v56
    v_exp_f32 v57, v57
    v_exp_f32 v58, v58
    v_exp_f32 v59, v59
    v_exp_f32 v60, v60
    v_exp_f32 v61, v61
    v_exp_f32 v62, v62
    v_exp_f32 v63, v63
    s_nop 0
    v_cvt_pk_bf16_f32 v36, v48, v49
    v_cvt_pk_bf16_f32 v37, v50, v51
    v_cvt_pk_bf16_f32 v38, v52, v53
    v_cvt_pk_bf16_f32 v39, v54, v55
    v_cvt_pk_bf16_f32 v40, v56, v57
    v_cvt_pk_bf16_f32 v41, v58, v59
    v_cvt_pk_bf16_f32 v42, v60, v61
    v_cvt_pk_bf16_f32 v43, v62, v63
    s_nop 1
    v_mfma_f32_32x32x16_bf16 v[80:95], v[20:23], v[36:39], v[80:95]
    v_mfma_f32_32x32x16_bf16 v[80:95], v[24:27], v[40:43], v[80:95]
    s_add_u32 s37, s37, 2048
    s_sub_u32 s45, s45, 1
    s_cmp_lg_u32 s45, 0
    s_cbranch_scc1 L_fb2
    s_nop 11
    s_branch L_a_fin
L_end:
    s_endpgm
.section .rodata,"a"
.p2align 6
.amdhsa_kernel parallel_sum__softmax_full_mha__glu_gated_geglu__prompt_kernel
  .amdhsa_next_free_vgpr 168
  .amdhsa_next_free_sgpr 102
  .amdhsa_accum_offset 168
  .amdhsa_group_segment_fixed_size 0
  .amdhsa_kernarg_size 80
  .amdhsa_user_sgpr_count 2
  .amdhsa_user_sgpr_kernarg_segment_ptr 1
  .amdhsa_system_sgpr_workgroup_id_x 1
.end_amdhsa_kernel
```
